```python
import torch

def _softmax(x, axis=-1):
    return torch.softmax(x, dim=axis)
def _gelu(x):
    return torch.nn.functional.gelu(x, approximate="tanh")
def _silu(x):
    return torch.nn.functional.silu(x)
def _sigmoid(x):
    return torch.sigmoid(x)
def _layernorm(x, axis=-1, eps=1e-5):
    m = x.mean(dim=axis, keepdim=True)
    v = x.var(dim=axis, keepdim=True, unbiased=False)
    return (x - m) / torch.sqrt(v + eps)
def _scatter_add(tgt, idx, src, axis=0):
    return tgt.clone().index_add_(axis, idx, src)
def _segment_sum(src, seg, n):
    out = torch.zeros((n,) + src.shape[1:], dtype=src.dtype)
    return out.index_add_(0, seg, src)
def _pad(x, pw):
    flat = tuple(v for pair in reversed(pw) for v in pair)
    return torch.nn.functional.pad(x, flat)

kernel_name = 'sequential_preLN__mha_block_cached__mixer_channel_mlp__decode'

def setup_inputs():

    _w = (lambda a: (lambda t: t.to(torch.bfloat16) if t.is_floating_point() else t)(torch.as_tensor(a)))
    def _A_setup():
        B, Sq, D = 2, 1, 512
        H, Sk, Dh = 32, 8192, 128
        return {
            "x": _w((lambda *s: torch.randn(*s, dtype=torch.bfloat16) * 0.05)(B, Sq, D)),
            "k_cache": _w((lambda *s: torch.randn(*s, dtype=torch.bfloat16) * 3.2)(B, H, Sk, Dh)),
            "v_cache": _w((lambda *s: torch.randn(*s, dtype=torch.bfloat16) * 0.4)(B, H, Sk, Dh)),
            "wq": _w((lambda *s: torch.randn(*s, dtype=torch.bfloat16) * 3.2)(D, H * Dh) * (D ** -0.5)),
            "wo": _w((lambda *s: torch.randn(*s, dtype=torch.bfloat16) * 0.4)(H * Dh, D) * ((H * Dh) ** -0.5)),
        }
    _A_in = _A_setup()

    def _B_setup():
        B, S, D, F = 2, 1, 512, 1792
        return {
            "x": _w((lambda *s: torch.randn(*s, dtype=torch.bfloat16) * 0.05)(B, S, D)),
            "w1": _w((lambda *s: torch.randn(*s, dtype=torch.bfloat16) * 3.2)(D, F) * (D ** -0.5)),
            "b1": _w((lambda *s: torch.randn(*s, dtype=torch.bfloat16) * 3.2)(F)),
            "w2": _w((lambda *s: torch.randn(*s, dtype=torch.bfloat16) * 0.8)(F, D) * (F ** -0.5)),
            "b2": _w((lambda *s: torch.randn(*s, dtype=torch.bfloat16) * 1.6)(D)),
        }
    _B_in = _B_setup()

    return {
        "A_x": _A_in["x"],
        "A_k_cache": _A_in["k_cache"],
        "A_v_cache": _A_in["v_cache"],
        "A_wq": _A_in["wq"],
        "A_wo": _A_in["wo"],
        "B_x": _B_in["x"],
        "B_w1": _B_in["w1"],
        "B_b1": _B_in["b1"],
        "B_w2": _B_in["w2"],
        "B_b2": _B_in["b2"],
    }

def reference(A_x, A_k_cache, A_v_cache, A_wq, A_wo, B_x, B_w1, B_b1, B_w2, B_b2):
    def _A_ref(x, k_cache, v_cache, wq, wo):
        B, Sq, D = x.shape
        H, Dh = 32, 128
        q = (lambda x, *d: x.permute(*d))((x @ wq).reshape(B, Sq, H, Dh), 0, 2, 1, 3)
        scores = torch.einsum("bhqd,bhkd->bhqk", q, k_cache) * (Dh ** -0.5)
        p = _softmax(scores, axis=-1)
        o = torch.einsum("bhqk,bhkd->bhqd", p, v_cache)
        return (lambda x, *d: x.permute(*d))(o, 0, 2, 1, 3).reshape(B, Sq, H * Dh) @ wo

    def _B_ref(x, w1, b1, w2, b2):
        y = _layernorm(x, axis=-1)
        h = _gelu(torch.einsum("bsd,df->bsf", y, w1) + b1)
        return torch.einsum("bsf,fd->bsd", h, w2) + b2

    x = A_x
    h = x + _A_ref(_layernorm(x, axis=-1), A_k_cache, A_v_cache, A_wq, A_wo)
    h2 = h + _B_ref(_layernorm(h, axis=-1), B_w1, B_b1, B_w2, B_b2)
    return h2
```

```asm
; @launch grid=(256,1,1) block=(256,1,1) lds=78400
.amdgcn_target "amdgcn-amd-amdhsa--gfx950"
.text
.globl sequential_preLN__mha_block_cached__mixer_channel_mlp__decode_kernel
.p2align 12
.fill 832, 4, 0xbf800000
.p2align 8
.type sequential_preLN__mha_block_cached__mixer_channel_mlp__decode_kernel,@function
sequential_preLN__mha_block_cached__mixer_channel_mlp__decode_kernel:
  s_cmp_ge_u32 s2, 256
  s_cbranch_scc1 L_end
  s_load_dwordx16 s[16:31], s[0:1], 0
  s_load_dwordx8 s[32:39], s[0:1], 64
  s_load_dwordx2 s[40:41], s[0:1], 96
  v_lshrrev_b32 v3, 6, v0
  v_and_b32 v2, 63, v0
  v_readfirstlane_b32 s3, v3
  v_lshlrev_b32 v1, 4, v2
  s_and_b32 s4, s2, 7
  s_lshr_b32 s5, s2, 3
  s_and_b32 s8, s5, 3
  s_lshr_b32 s10, s5, 2
  s_and_b32 s6, s10, 1
  s_lshr_b32 s10, s10, 1
  s_lshl_b32 s7, s4, 2
  s_add_u32 s7, s7, s10
  s_and_b32 s91, s5, 7
  s_lshl_b32 s91, s91, 2
  s_mov_b32 s90, 0
  s_lshl_b32 s9, s7, 2
  s_add_u32 s9, s9, s8
  s_mov_b32 s84, 0
  s_mov_b32 s85, 0
  s_cmp_lt_u32 s2, 28
  s_cselect_b32 s84, 2, s84
  s_cselect_b32 s85, s2, s85
  s_sub_u32 s11, s2, 64
  s_cmp_lt_u32 s11, 64
  s_cselect_b32 s84, 1, s84
  s_cselect_b32 s85, s11, s85
  v_lshrrev_b32 v42, 4, v2
  v_and_b32 v43, 15, v2
  v_lshlrev_b32 v3, 13, v42
  v_lshl_or_b32 v3, v43, 4, v3
  s_lshl_b32 s68, s6, 10
  s_lshl_b32 s52, s7, 8
  s_lshl_b32 s11, s3, 20
  s_add_u32 s52, s52, s11
  s_lshl_b32 s44, s6, 5
  s_add_u32 s44, s44, s7
  s_lshl_b32 s44, s44, 21
  s_lshl_b32 s11, s8, 14
  s_add_u32 s44, s44, s11
  s_lshl_b32 s11, s3, 12
  s_add_u32 s44, s44, s11
  s_mov_b32 s48, s44
  s_sub_u32 s46, 0x8000000, s44
  s_mov_b32 s50, s46
  s_sub_u32 s54, 0x400000, s52
  s_mov_b32 s71, 0x00020000
  s_mov_b32 s55, 0x00020000
  s_mov_b32 s47, 0x00020000
  s_mov_b32 s51, 0x00020000
  s_mov_b32 s79, 0x00020000
  s_mov_b32 s70, 1024
  s_mov_b32 s78, 659456
  s_lshl_b32 s82, s91, 15
  s_lshl_b32 s80, s7, 16
  s_mov_b32 s81, s80
  s_mov_b32 s86, 0xaaaaaaaa
  s_mov_b32 s87, 0xaaaaaaaa
  s_mov_b32 s88, 0xcccccccc
  s_mov_b32 s89, 0xcccccccc
  v_and_b32 v44, 1, v43
  v_lshlrev_b32 v44, 4, v44
  v_mov_b32 v45, 0xffff
  v_lshlrev_b32 v44, v44, v45
  v_lshrrev_b32 v45, 1, v43
  v_and_b32 v46, 3, v45
  v_cmp_eq_u32 vcc, 0, v45
  s_nop 1
  v_cndmask_b32 v8, 0, v44, vcc
  v_cmp_eq_u32 vcc, 0, v46
  s_nop 1
  v_cndmask_b32 v192, 0, v44, vcc
  v_cmp_eq_u32 vcc, 1, v45
  s_nop 1
  v_cndmask_b32 v9, 0, v44, vcc
  v_cmp_eq_u32 vcc, 1, v46
  s_nop 1
  v_cndmask_b32 v193, 0, v44, vcc
  v_cmp_eq_u32 vcc, 2, v45
  s_nop 1
  v_cndmask_b32 v10, 0, v44, vcc
  v_cmp_eq_u32 vcc, 2, v46
  s_nop 1
  v_cndmask_b32 v194, 0, v44, vcc
  v_cmp_eq_u32 vcc, 3, v45
  s_nop 1
  v_cndmask_b32 v11, 0, v44, vcc
  v_cmp_eq_u32 vcc, 3, v46
  s_nop 1
  v_cndmask_b32 v195, 0, v44, vcc
  s_waitcnt lgkmcnt(0)
  s_add_u32 s68, s16, s68
  s_addc_u32 s69, s17, 0
  buffer_load_dwordx4 v[60:63], v1, s[68:71], 0 offen
  s_add_u32 s44, s18, s44
  s_addc_u32 s45, s19, 0
  s_add_u32 s48, s20, s48
  s_addc_u32 s49, s21, 0
  s_add_u32 s52, s22, s52
  s_addc_u32 s53, s23, 0
  s_load_dword s26, s[40:41], 0xc0000
  buffer_load_dwordx4 a[64:67], v3, s[52:55], s82 offen
  s_add_u32 s82, s82, 0x8000
  s_and_b32 s82, s82, 0xfffff
  buffer_load_dwordx4 a[68:71], v3, s[52:55], s82 offen
  s_add_u32 s82, s82, 0x8000
  s_and_b32 s82, s82, 0xfffff
  buffer_load_dwordx4 v[128:131], v1, s[44:47], s80 offen nt
  buffer_load_dwordx4 v[132:135], v1, s[44:47], s80 offen offset:1024 nt
  buffer_load_dwordx4 v[136:139], v1, s[44:47], s80 offen offset:2048 nt
  buffer_load_dwordx4 a[72:75], v3, s[52:55], s82 offen
  s_add_u32 s82, s82, 0x8000
  s_and_b32 s82, s82, 0xfffff
  buffer_load_dwordx4 a[76:79], v3, s[52:55], s82 offen
  s_add_u32 s82, s82, 0x8000
  s_and_b32 s82, s82, 0xfffff
  buffer_load_dwordx4 v[140:143], v1, s[44:47], s80 offen offset:3072 nt
  s_add_u32 s80, s80, 0x10000
  s_and_b32 s80, s80, 0x1fffff
  buffer_load_dwordx4 v[144:147], v1, s[44:47], s80 offen nt
  buffer_load_dwordx4 v[148:151], v1, s[44:47], s80 offen offset:1024 nt
  buffer_load_dwordx4 a[80:83], v3, s[52:55], s82 offen
  s_add_u32 s82, s82, 0x8000
  s_and_b32 s82, s82, 0xfffff
  buffer_load_dwordx4 a[84:87], v3, s[52:55], s82 offen
  s_add_u32 s82, s82, 0x8000
  s_and_b32 s82, s82, 0xfffff
  s_lshl_b32 s10, s7, 17
  s_lshl_b32 s11, s3, 8
  s_add_u32 s10, s10, s11
  s_sub_u32 s11, 0x400000, s10
  s_add_u32 s56, s24, s10
  s_addc_u32 s57, s25, 0
  s_mov_b32 s58, s11
  s_mov_b32 s59, 0x00020000
  s_mov_b32 s60, s40
  s_mov_b32 s61, s41
  s_mov_b32 s62, 16777216
  s_mov_b32 s63, 0x00020000
  s_mov_b32 s72, s38
  s_mov_b32 s73, s39
  s_mov_b32 s74, 256
  s_mov_b32 s75, 0x00020000
  s_lshl_b32 s10, s85, 7
  s_mul_i32 s11, s3, 458752
  s_add_u32 s10, s10, s11
  s_sub_u32 s11, 1835008, s10
  s_cmp_eq_u32 s84, 2
  s_cselect_b32 s10, s10, 0
  s_cselect_b32 s11, s11, 0
  s_add_u32 s64, s28, s10
  s_addc_u32 s65, s29, 0
  s_mov_b32 s66, s11
  s_mov_b32 s67, 0x00020000
  s_lshl_b32 s10, s85, 16
  s_lshl_b32 s11, s3, 8
  s_add_u32 s10, s10, s11
  s_sub_u32 s11, 1835008, s10
  s_cmp_eq_u32 s84, 2
  s_cselect_b32 s10, s10, 0
  s_cselect_b32 s11, s11, 0
  s_add_u32 s92, s32, s10
  s_addc_u32 s93, s33, 0
  s_mov_b32 s94, s11
  s_mov_b32 s95, 0x00020000
  s_cmp_eq_u32 s84, 2
  s_cselect_b32 s96, s30, s34
  s_cselect_b32 s97, s31, s35
  s_mov_b32 s14, 3584
  s_cselect_b32 s98, s14, 1024
  s_mov_b32 s99, 0x00020000
  v_lshrrev_b32 v44, 3, v2
  v_mul_u32_u24 v197, 3584, v44
  v_bfe_u32 v44, v2, 4, 1
  v_lshlrev_b32 v44, 1, v44
  v_and_b32 v45, 7, v2
  v_xor_b32 v44, v44, v45
  v_xor_b32 v45, 4, v44
  v_lshl_add_u32 v198, v45, 4, v197
  v_lshl_add_u32 v197, v44, 4, v197
  v_lshlrev_b32 v199, 14, v42
  v_lshl_or_b32 v199, v43, 4, v199
  s_lshl_b32 s10, s3, 11
  s_add_u32 s10, s10, 65536
  v_add_u32 v49, s10, v1
  s_lshl_b32 s11, s3, 8
  s_add_u32 s10, s10, s11
  v_add_u32 v50, s91, v43
  v_and_b32 v50, 31, v50
  v_lshlrev_b32 v50, 3, v50
  v_lshl_or_b32 v50, v42, 1, v50
  v_add_u32 v50, s10, v50
  v_add_u32 v51, s91, v43
  v_add_u32 v51, 16, v51
  v_and_b32 v51, 31, v51
  v_lshlrev_b32 v51, 3, v51
  v_lshl_or_b32 v51, v42, 1, v51
  v_add_u32 v51, s10, v51
  s_lshr_b32 s10, s2, 5
  s_cmp_lg_u32 s10, 1
  s_cbranch_scc1 L_noprobe_1
  s_and_b32 s10, s2, 31
  s_lshl_b32 s10, s10, 2
  s_add_u32 s10, s10, s3
  s_lshr_b32 s12, s10, 6
  s_lshl_b32 s12, s12, 14
  s_and_b32 s13, s10, 63
  s_lshl_b32 s13, s13, 7
  s_add_u32 s12, s12, s13
  s_add_u32 s12, s12, 0x120000
  s_lshr_b32 s13, s2, 2
  s_xor_b32 s13, s13, s3
  s_and_b32 s13, s13, 1
  s_lshl_b32 s13, s13, 13
  s_add_u32 s12, s12, s13
  s_waitcnt lgkmcnt(0)
  s_memtime s[14:15]
  s_waitcnt lgkmcnt(0)
  s_load_dword s10, s[40:41], s12
  s_waitcnt lgkmcnt(0)
  s_memtime s[10:11]
  s_waitcnt lgkmcnt(0)
  s_sub_u32 s27, s10, s14
L_noprobe_1:
  s_waitcnt vmcnt(12)
  s_lshr_b32 s10, s2, 5
  s_cmp_lg_u32 s10, 1
  s_cbranch_scc1 L_novote_2
  s_add_u32 s10, s26, 1
  s_mul_i32 s10, s10, 0x9e3779b1
  s_and_b32 s11, s2, 31
  s_lshl_b32 s11, s11, 2
  s_add_u32 s11, s11, s3
  s_lshl_b32 s11, s11, 3
  s_add_u32 s11, s11, 0xc1000
  v_mov_b32 v240, s10
  v_mov_b32 v241, s27
  v_mov_b32 v242, s11
  s_mov_b32 exec_lo, 0x1
  s_mov_b32 exec_hi, 0x0
  buffer_store_dwordx2 v[240:241], v242, s[60:63], 0 offen sc1
  s_mov_b64 exec, -1
L_novote_2:
  v_lshlrev_b32 v24, 16, v60
  v_and_b32 v25, 0xffff0000, v60
  v_lshlrev_b32 v26, 16, v61
  v_and_b32 v27, 0xffff0000, v61
  v_lshlrev_b32 v28, 16, v62
  v_and_b32 v29, 0xffff0000, v62
  v_lshlrev_b32 v30, 16, v63
  v_and_b32 v31, 0xffff0000, v63
  v_add_f32 v42, v24, v25
  v_add_f32 v43, v26, v27
  v_add_f32 v42, v42, v28
  v_add_f32 v43, v43, v29
  v_add_f32 v42, v42, v30
  v_add_f32 v43, v43, v31
  v_add_f32 v42, v42, v43
  s_nop 1
  v_add_f32_dpp v42, v42, v42 row_ror:8 row_mask:0xf bank_mask:0xf
  s_nop 1
  v_add_f32_dpp v42, v42, v42 row_ror:4 row_mask:0xf bank_mask:0xf
  s_nop 1
  v_add_f32_dpp v42, v42, v42 row_ror:2 row_mask:0xf bank_mask:0xf
  s_nop 1
  v_add_f32_dpp v42, v42, v42 row_ror:1 row_mask:0xf bank_mask:0xf
  v_mov_b32 v43, v42
  s_nop 1
  v_permlane16_swap_b32 v42, v43
  s_nop 0
  v_add_f32 v42, v42, v43
  v_mov_b32 v43, v42
  s_nop 1
  v_permlane32_swap_b32 v42, v43
  s_nop 0
  v_add_f32 v42, v42, v43
  v_mul_f32 v42, 0x3b000000, v42
  v_sub_f32 v44, v24, v42
  v_mul_f32 v43, v44, v44
  v_sub_f32 v44, v25, v42
  v_fma_f32 v43, v44, v44, v43
  v_sub_f32 v44, v26, v42
  v_fma_f32 v43, v44, v44, v43
  v_sub_f32 v44, v27, v42
  v_fma_f32 v43, v44, v44, v43
  v_sub_f32 v44, v28, v42
  v_fma_f32 v43, v44, v44, v43
  v_sub_f32 v44, v29, v42
  v_fma_f32 v43, v44, v44, v43
  v_sub_f32 v44, v30, v42
  v_fma_f32 v43, v44, v44, v43
  v_sub_f32 v44, v31, v42
  v_fma_f32 v43, v44, v44, v43
  s_nop 1
  v_add_f32_dpp v43, v43, v43 row_ror:8 row_mask:0xf bank_mask:0xf
  s_nop 1
  v_add_f32_dpp v43, v43, v43 row_ror:4 row_mask:0xf bank_mask:0xf
  s_nop 1
  v_add_f32_dpp v43, v43, v43 row_ror:2 row_mask:0xf bank_mask:0xf
  s_nop 1
  v_add_f32_dpp v43, v43, v43 row_ror:1 row_mask:0xf bank_mask:0xf
  v_mov_b32 v44, v43
  s_nop 1
  v_permlane16_swap_b32 v43, v44
  s_nop 0
  v_add_f32 v43, v43, v44
  v_mov_b32 v44, v43
  s_nop 1
  v_permlane32_swap_b32 v43, v44
  s_nop 0
  v_add_f32 v43, v43, v44
  v_mul_f32 v43, 0x3b000000, v43
  v_cvt_pk_bf16_f32 v42, v42, v42
  v_and_b32 v42, 0xffff0000, v42
  v_cvt_pk_bf16_f32 v43, v43, v43
  v_and_b32 v43, 0xffff0000, v43
  v_add_f32 v43, 0x3727c5ac, v43
  v_cvt_pk_bf16_f32 v43, v43, v43
  v_and_b32 v43, 0xffff0000, v43
  v_sqrt_f32 v43, v43
  s_nop 0
  v_cvt_pk_bf16_f32 v43, v43, v43
  v_and_b32 v43, 0xffff0000, v43
  v_rcp_f32 v43, v43
  s_nop 0
  v_sub_f32 v24, v24, v42
  v_sub_f32 v25, v25, v42
  v_sub_f32 v26, v26, v42
  v_sub_f32 v27, v27, v42
  v_sub_f32 v28, v28, v42
  v_sub_f32 v29, v29, v42
  v_sub_f32 v30, v30, v42
  v_sub_f32 v31, v31, v42
  v_cvt_pk_bf16_f32 v60, v24, v25
  v_cvt_pk_bf16_f32 v61, v26, v27
  v_cvt_pk_bf16_f32 v62, v28, v29
  v_cvt_pk_bf16_f32 v63, v30, v31
  v_lshlrev_b32 v24, 16, v60
  v_and_b32 v25, 0xffff0000, v60
  v_lshlrev_b32 v26, 16, v61
  v_and_b32 v27, 0xffff0000, v61
  v_lshlrev_b32 v28, 16, v62
  v_and_b32 v29, 0xffff0000, v62
  v_lshlrev_b32 v30, 16, v63
  v_and_b32 v31, 0xffff0000, v63
  v_mul_f32 v24, v24, v43
  v_mul_f32 v25, v25, v43
  v_mul_f32 v26, v26, v43
  v_mul_f32 v27, v27, v43
  v_mul_f32 v28, v28, v43
  v_mul_f32 v29, v29, v43
  v_mul_f32 v30, v30, v43
  v_mul_f32 v31, v31, v43
  v_cvt_pk_bf16_f32 v60, v24, v25
  v_cvt_pk_bf16_f32 v61, v26, v27
  v_cvt_pk_bf16_f32 v62, v28, v29
  v_cvt_pk_bf16_f32 v63, v30, v31
  ds_write_b128 v49, v[60:63]
  s_waitcnt lgkmcnt(0)
  ds_read_u16 v48, v50
  ds_read_u16 v49, v51
  s_waitcnt lgkmcnt(0)
  v_lshl_or_b32 v48, v48, 16, v48
  v_lshl_or_b32 v49, v49, 16, v49
  s_nop 1
  v_and_b32_dpp v16, v48, v8 row_newbcast:0 row_mask:0xf bank_mask:0xf
  v_and_b32_dpp v17, v48, v9 row_newbcast:0 row_mask:0xf bank_mask:0xf
  v_and_b32_dpp v18, v48, v10 row_newbcast:0 row_mask:0xf bank_mask:0xf
  v_and_b32_dpp v19, v48, v11 row_newbcast:0 row_mask:0xf bank_mask:0xf
  v_and_b32_dpp v20, v48, v8 row_newbcast:1 row_mask:0xf bank_mask:0xf
  v_and_b32_dpp v21, v48, v9 row_newbcast:1 row_mask:0xf bank_mask:0xf
  v_and_b32_dpp v22, v48, v10 row_newbcast:1 row_mask:0xf bank_mask:0xf
  v_and_b32_dpp v23, v48, v11 row_newbcast:1 row_mask:0xf bank_mask:0xf
  s_waitcnt vmcnt(11)
  v_mfma_f32_16x16x32_bf16 v[12:15], v[16:19], a[64:67], 0
  v_and_b32_dpp v16, v48, v8 row_newbcast:2 row_mask:0xf bank_mask:0xf
  v_and_b32_dpp v17, v48, v9 row_newbcast:2 row_mask:0xf bank_mask:0xf
  v_and_b32_dpp v18, v48, v10 row_newbcast:2 row_mask:0xf bank_mask:0xf
  v_and_b32_dpp v19, v48, v11 row_newbcast:2 row_mask:0xf bank_mask:0xf
  buffer_load_dwordx4 v[152:155], v1, s[44:47], s80 offen offset:2048 nt
  buffer_load_dwordx4 v[156:159], v1, s[44:47], s80 offen offset:3072 nt
  s_add_u32 s80, s80, 0x10000
  s_and_b32 s80, s80, 0x1fffff
  buffer_load_dwordx4 v[160:163], v1, s[44:47], s80 offen nt
  buffer_load_dwordx4 a[88:91], v3, s[52:55], s82 offen
  s_add_u32 s82, s82, 0x8000
  s_and_b32 s82, s82, 0xfffff
  s_waitcnt vmcnt(14)
  v_mfma_f32_16x16x32_bf16 v[12:15], v[20:23], a[68:71], v[12:15]
  v_and_b32_dpp v20, v48, v8 row_newbcast:3 row_mask:0xf bank_mask:0xf
  v_and_b32_dpp v21, v48, v9 row_newbcast:3 row_mask:0xf bank_mask:0xf
  v_and_b32_dpp v22, v48, v10 row_newbcast:3 row_mask:0xf bank_mask:0xf
  v_and_b32_dpp v23, v48, v11 row_newbcast:3 row_mask:0xf bank_mask:0xf
  buffer_load_dwordx4 a[92:95], v3, s[52:55], s82 offen
  s_add_u32 s82, s82, 0x8000
  s_and_b32 s82, s82, 0xfffff
  s_cmp_eq_u32 s3, 0
  s_cbranch_scc1 L_stub_0
  s_cmp_eq_u32 s3, 1
  s_cbranch_scc1 L_stub_1
  s_cmp_eq_u32 s3, 2
  s_cbranch_scc1 L_stub_2
  s_cmp_eq_u32 s3, 3
  s_cbranch_scc1 L_stub_3
L_back_0:
  s_waitcnt vmcnt(11)
  v_mfma_f32_16x16x32_bf16 v[12:15], v[16:19], a[72:75], v[12:15]
  v_and_b32_dpp v16, v48, v8 row_newbcast:4 row_mask:0xf bank_mask:0xf
  v_and_b32_dpp v17, v48, v9 row_newbcast:4 row_mask:0xf bank_mask:0xf
  v_and_b32_dpp v18, v48, v10 row_newbcast:4 row_mask:0xf bank_mask:0xf
  v_and_b32_dpp v19, v48, v11 row_newbcast:4 row_mask:0xf bank_mask:0xf
  buffer_load_dwordx4 v[164:167], v1, s[44:47], s80 offen offset:1024 nt
  buffer_load_dwordx4 v[168:171], v1, s[44:47], s80 offen offset:2048 nt
  buffer_load_dwordx4 v[172:175], v1, s[44:47], s80 offen offset:3072 nt
  buffer_load_dwordx4 a[96:99], v3, s[52:55], s82 offen
  s_add_u32 s82, s82, 0x8000
  s_and_b32 s82, s82, 0xfffff
  s_waitcnt vmcnt(14)
  v_mfma_f32_16x16x32_bf16 v[12:15], v[20:23], a[76:79], v[12:15]
  v_and_b32_dpp v20, v48, v8 row_newbcast:5 row_mask:0xf bank_mask:0xf
  v_and_b32_dpp v21, v48, v9 row_newbcast:5 row_mask:0xf bank_mask:0xf
  v_and_b32_dpp v22, v48, v10 row_newbcast:5 row_mask:0xf bank_mask:0xf
  v_and_b32_dpp v23, v48, v11 row_newbcast:5 row_mask:0xf bank_mask:0xf
  buffer_load_dwordx4 a[100:103], v3, s[52:55], s82 offen
  s_add_u32 s82, s82, 0x8000
  s_and_b32 s82, s82, 0xfffff
  s_waitcnt vmcnt(11)
  v_mfma_f32_16x16x32_bf16 v[12:15], v[16:19], a[80:83], v[12:15]
  v_and_b32_dpp v16, v48, v8 row_newbcast:6 row_mask:0xf bank_mask:0xf
  v_and_b32_dpp v17, v48, v9 row_newbcast:6 row_mask:0xf bank_mask:0xf
  v_and_b32_dpp v18, v48, v10 row_newbcast:6 row_mask:0xf bank_mask:0xf
  v_and_b32_dpp v19, v48, v11 row_newbcast:6 row_mask:0xf bank_mask:0xf
  s_add_u32 s80, s80, 0x10000
  s_and_b32 s80, s80, 0x1fffff
  buffer_load_dwordx4 v[176:179], v1, s[44:47], s80 offen nt
  buffer_load_dwordx4 v[180:183], v1, s[44:47], s80 offen offset:1024 nt
  buffer_load_dwordx4 v[184:187], v1, s[44:47], s80 offen offset:2048 nt
  buffer_load_dwordx4 a[104:107], v3, s[52:55], s82 offen
  s_add_u32 s82, s82, 0x8000
  s_and_b32 s82, s82, 0xfffff
  s_waitcnt vmcnt(14)
  v_mfma_f32_16x16x32_bf16 v[12:15], v[20:23], a[84:87], v[12:15]
  v_and_b32_dpp v20, v48, v8 row_newbcast:7 row_mask:0xf bank_mask:0xf
  v_and_b32_dpp v21, v48, v9 row_newbcast:7 row_mask:0xf bank_mask:0xf
  v_and_b32_dpp v22, v48, v10 row_newbcast:7 row_mask:0xf bank_mask:0xf
  v_and_b32_dpp v23, v48, v11 row_newbcast:7 row_mask:0xf bank_mask:0xf
  buffer_load_dwordx4 a[108:111], v3, s[52:55], s82 offen
  s_add_u32 s82, s82, 0x8000
  s_and_b32 s82, s82, 0xfffff
  s_waitcnt vmcnt(11)
  v_mfma_f32_16x16x32_bf16 v[12:15], v[16:19], a[88:91], v[12:15]
  v_and_b32_dpp v16, v48, v8 row_newbcast:8 row_mask:0xf bank_mask:0xf
  v_and_b32_dpp v17, v48, v9 row_newbcast:8 row_mask:0xf bank_mask:0xf
  v_and_b32_dpp v18, v48, v10 row_newbcast:8 row_mask:0xf bank_mask:0xf
  v_and_b32_dpp v19, v48, v11 row_newbcast:8 row_mask:0xf bank_mask:0xf
  buffer_load_dwordx4 v[188:191], v1, s[44:47], s80 offen offset:3072 nt
  buffer_load_dwordx4 a[192:195], v1, s[48:51], s81 offen nt
  buffer_load_dwordx4 a[196:199], v1, s[48:51], s81 offen offset:1024 nt
  buffer_load_dwordx4 a[112:115], v3, s[52:55], s82 offen
  s_add_u32 s82, s82, 0x8000
  s_and_b32 s82, s82, 0xfffff
  s_waitcnt vmcnt(14)
  v_mfma_f32_16x16x32_bf16 v[12:15], v[20:23], a[92:95], v[12:15]
  v_and_b32_dpp v20, v48, v8 row_newbcast:9 row_mask:0xf bank_mask:0xf
  v_and_b32_dpp v21, v48, v9 row_newbcast:9 row_mask:0xf bank_mask:0xf
  v_and_b32_dpp v22, v48, v10 row_newbcast:9 row_mask:0xf bank_mask:0xf
  v_and_b32_dpp v23, v48, v11 row_newbcast:9 row_mask:0xf bank_mask:0xf
  buffer_load_dwordx4 a[116:119], v3, s[52:55], s82 offen
  s_add_u32 s82, s82, 0x8000
  s_and_b32 s82, s82, 0xfffff
  s_waitcnt vmcnt(11)
  v_mfma_f32_16x16x32_bf16 v[12:15], v[16:19], a[96:99], v[12:15]
  v_and_b32_dpp v16, v48, v8 row_newbcast:10 row_mask:0xf bank_mask:0xf
  v_and_b32_dpp v17, v48, v9 row_newbcast:10 row_mask:0xf bank_mask:0xf
  v_and_b32_dpp v18, v48, v10 row_newbcast:10 row_mask:0xf bank_mask:0xf
  v_and_b32_dpp v19, v48, v11 row_newbcast:10 row_mask:0xf bank_mask:0xf
  buffer_load_dwordx4 a[200:203], v1, s[48:51], s81 offen offset:2048 nt
  buffer_load_dwordx4 a[204:207], v1, s[48:51], s81 offen offset:3072 nt
  s_add_u32 s81, s81, 0x10000
  s_and_b32 s81, s81, 0x1fffff
  buffer_load_dwordx4 a[208:211], v1, s[48:51], s81 offen nt
  buffer_load_dwordx4 a[120:123], v3, s[52:55], s82 offen
  s_add_u32 s82, s82, 0x8000
  s_and_b32 s82, s82, 0xfffff
  s_waitcnt vmcnt(14)
  v_mfma_f32_16x16x32_bf16 v[12:15], v[20:23], a[100:103], v[12:15]
  v_and_b32_dpp v20, v48, v8 row_newbcast:11 row_mask:0xf bank_mask:0xf
  v_and_b32_dpp v21, v48, v9 row_newbcast:11 row_mask:0xf bank_mask:0xf
  v_and_b32_dpp v22, v48, v10 row_newbcast:11 row_mask:0xf bank_mask:0xf
  v_and_b32_dpp v23, v48, v11 row_newbcast:11 row_mask:0xf bank_mask:0xf
  buffer_load_dwordx4 a[124:127], v3, s[52:55], s82 offen
  s_add_u32 s82, s82, 0x8000
  s_and_b32 s82, s82, 0xfffff
  s_waitcnt vmcnt(11)
  v_mfma_f32_16x16x32_bf16 v[12:15], v[16:19], a[104:107], v[12:15]
  v_and_b32_dpp v16, v48, v8 row_newbcast:12 row_mask:0xf bank_mask:0xf
  v_and_b32_dpp v17, v48, v9 row_newbcast:12 row_mask:0xf bank_mask:0xf
  v_and_b32_dpp v18, v48, v10 row_newbcast:12 row_mask:0xf bank_mask:0xf
  v_and_b32_dpp v19, v48, v11 row_newbcast:12 row_mask:0xf bank_mask:0xf
  buffer_load_dwordx4 a[212:215], v1, s[48:51], s81 offen offset:1024 nt
  buffer_load_dwordx4 a[216:219], v1, s[48:51], s81 offen offset:2048 nt
  buffer_load_dwordx4 a[220:223], v1, s[48:51], s81 offen offset:3072 nt
  buffer_load_dwordx4 a[128:131], v3, s[52:55], s82 offen
  s_add_u32 s82, s82, 0x8000
  s_and_b32 s82, s82, 0xfffff
  s_waitcnt vmcnt(14)
  v_mfma_f32_16x16x32_bf16 v[12:15], v[20:23], a[108:111], v[12:15]
  v_and_b32_dpp v20, v48, v8 row_newbcast:13 row_mask:0xf bank_mask:0xf
  v_and_b32_dpp v21, v48, v9 row_newbcast:13 row_mask:0xf bank_mask:0xf
  v_and_b32_dpp v22, v48, v10 row_newbcast:13 row_mask:0xf bank_mask:0xf
  v_and_b32_dpp v23, v48, v11 row_newbcast:13 row_mask:0xf bank_mask:0xf
  buffer_load_dwordx4 a[132:135], v3, s[52:55], s82 offen
  s_add_u32 s82, s82, 0x8000
  s_and_b32 s82, s82, 0xfffff
  s_cmp_eq_u32 s3, 0
  s_cbranch_scc1 L_stub_4
  s_cmp_eq_u32 s3, 1
  s_cbranch_scc1 L_stub_5
  s_cmp_eq_u32 s3, 2
  s_cbranch_scc1 L_stub_6
L_back_1:
  s_waitcnt vmcnt(11)
  v_mfma_f32_16x16x32_bf16 v[12:15], v[16:19], a[112:115], v[12:15]
  v_and_b32_dpp v16, v48, v8 row_newbcast:14 row_mask:0xf bank_mask:0xf
  v_and_b32_dpp v17, v48, v9 row_newbcast:14 row_mask:0xf bank_mask:0xf
  v_and_b32_dpp v18, v48, v10 row_newbcast:14 row_mask:0xf bank_mask:0xf
  v_and_b32_dpp v19, v48, v11 row_newbcast:14 row_mask:0xf bank_mask:0xf
  s_add_u32 s81, s81, 0x10000
  s_and_b32 s81, s81, 0x1fffff
  buffer_load_dwordx4 a[224:227], v1, s[48:51], s81 offen nt
  buffer_load_dwordx4 a[228:231], v1, s[48:51], s81 offen offset:1024 nt
  buffer_load_dwordx4 a[232:235], v1, s[48:51], s81 offen offset:2048 nt
  buffer_load_dwordx4 a[136:139], v3, s[52:55], s82 offen
  s_add_u32 s82, s82, 0x8000
  s_and_b32 s82, s82, 0xfffff
  s_waitcnt vmcnt(14)
  v_mfma_f32_16x16x32_bf16 v[12:15], v[20:23], a[116:119], v[12:15]
  v_and_b32_dpp v20, v48, v8 row_newbcast:15 row_mask:0xf bank_mask:0xf
  v_and_b32_dpp v21, v48, v9 row_newbcast:15 row_mask:0xf bank_mask:0xf
  v_and_b32_dpp v22, v48, v10 row_newbcast:15 row_mask:0xf bank_mask:0xf
  v_and_b32_dpp v23, v48, v11 row_newbcast:15 row_mask:0xf bank_mask:0xf
  buffer_load_dwordx4 a[140:143], v3, s[52:55], s82 offen
  s_add_u32 s82, s82, 0x8000
  s_and_b32 s82, s82, 0xfffff
  s_waitcnt vmcnt(11)
  v_mfma_f32_16x16x32_bf16 v[12:15], v[16:19], a[120:123], v[12:15]
  v_and_b32_dpp v16, v49, v8 row_newbcast:0 row_mask:0xf bank_mask:0xf
  v_and_b32_dpp v17, v49, v9 row_newbcast:0 row_mask:0xf bank_mask:0xf
  v_and_b32_dpp v18, v49, v10 row_newbcast:0 row_mask:0xf bank_mask:0xf
  v_and_b32_dpp v19, v49, v11 row_newbcast:0 row_mask:0xf bank_mask:0xf
  buffer_load_dwordx4 a[236:239], v1, s[48:51], s81 offen offset:3072 nt
  s_add_u32 s81, s81, 0x10000
  s_and_b32 s81, s81, 0x1fffff
  buffer_load_dwordx4 a[240:243], v1, s[48:51], s81 offen nt
  buffer_load_dwordx4 a[244:247], v1, s[48:51], s81 offen offset:1024 nt
  buffer_load_dwordx4 a[144:147], v3, s[52:55], s82 offen
  s_add_u32 s82, s82, 0x8000
  s_and_b32 s82, s82, 0xfffff
  s_waitcnt vmcnt(14)
  v_mfma_f32_16x16x32_bf16 v[12:15], v[20:23], a[124:127], v[12:15]
  v_and_b32_dpp v20, v49, v8 row_newbcast:1 row_mask:0xf bank_mask:0xf
  v_and_b32_dpp v21, v49, v9 row_newbcast:1 row_mask:0xf bank_mask:0xf
  v_and_b32_dpp v22, v49, v10 row_newbcast:1 row_mask:0xf bank_mask:0xf
  v_and_b32_dpp v23, v49, v11 row_newbcast:1 row_mask:0xf bank_mask:0xf
  buffer_load_dwordx4 a[148:151], v3, s[52:55], s82 offen
  s_add_u32 s82, s82, 0x8000
  s_and_b32 s82, s82, 0xfffff
  s_waitcnt vmcnt(11)
  v_mfma_f32_16x16x32_bf16 v[12:15], v[16:19], a[128:131], v[12:15]
  v_and_b32_dpp v16, v49, v8 row_newbcast:2 row_mask:0xf bank_mask:0xf
  v_and_b32_dpp v17, v49, v9 row_newbcast:2 row_mask:0xf bank_mask:0xf
  v_and_b32_dpp v18, v49, v10 row_newbcast:2 row_mask:0xf bank_mask:0xf
  v_and_b32_dpp v19, v49, v11 row_newbcast:2 row_mask:0xf bank_mask:0xf
  buffer_load_dwordx4 a[248:251], v1, s[48:51], s81 offen offset:2048 nt
  buffer_load_dwordx4 a[252:255], v1, s[48:51], s81 offen offset:3072 nt
  s_add_u32 s80, s80, 0x10000
  s_and_b32 s80, s80, 0x1fffff
  buffer_load_dwordx4 v[64:67], v1, s[44:47], s80 offen nt
  buffer_load_dwordx4 a[152:155], v3, s[52:55], s82 offen
  s_add_u32 s82, s82, 0x8000
  s_and_b32 s82, s82, 0xfffff
  s_waitcnt vmcnt(14)
  v_mfma_f32_16x16x32_bf16 v[12:15], v[20:23], a[132:135], v[12:15]
  v_and_b32_dpp v20, v49, v8 row_newbcast:3 row_mask:0xf bank_mask:0xf
  v_and_b32_dpp v21, v49, v9 row_newbcast:3 row_mask:0xf bank_mask:0xf
  v_and_b32_dpp v22, v49, v10 row_newbcast:3 row_mask:0xf bank_mask:0xf
  v_and_b32_dpp v23, v49, v11 row_newbcast:3 row_mask:0xf bank_mask:0xf
  buffer_load_dwordx4 a[156:159], v3, s[52:55], s82 offen
  s_add_u32 s82, s82, 0x8000
  s_and_b32 s82, s82, 0xfffff
  s_waitcnt vmcnt(11)
  v_mfma_f32_16x16x32_bf16 v[12:15], v[16:19], a[136:139], v[12:15]
  v_and_b32_dpp v16, v49, v8 row_newbcast:4 row_mask:0xf bank_mask:0xf
  v_and_b32_dpp v17, v49, v9 row_newbcast:4 row_mask:0xf bank_mask:0xf
  v_and_b32_dpp v18, v49, v10 row_newbcast:4 row_mask:0xf bank_mask:0xf
  v_and_b32_dpp v19, v49, v11 row_newbcast:4 row_mask:0xf bank_mask:0xf
  buffer_load_dwordx4 v[68:71], v1, s[44:47], s80 offen offset:1024 nt
  buffer_load_dwordx4 v[72:75], v1, s[44:47], s80 offen offset:2048 nt
  buffer_load_dwordx4 v[76:79], v1, s[44:47], s80 offen offset:3072 nt
  buffer_load_dwordx4 a[160:163], v3, s[52:55], s82 offen
  s_add_u32 s82, s82, 0x8000
  s_and_b32 s82, s82, 0xfffff
  s_waitcnt vmcnt(14)
  v_mfma_f32_16x16x32_bf16 v[12:15], v[20:23], a[140:143], v[12:15]
  v_and_b32_dpp v20, v49, v8 row_newbcast:5 row_mask:0xf bank_mask:0xf
  v_and_b32_dpp v21, v49, v9 row_newbcast:5 row_mask:0xf bank_mask:0xf
  v_and_b32_dpp v22, v49, v10 row_newbcast:5 row_mask:0xf bank_mask:0xf
  v_and_b32_dpp v23, v49, v11 row_newbcast:5 row_mask:0xf bank_mask:0xf
  buffer_load_dwordx4 a[164:167], v3, s[52:55], s82 offen
  s_add_u32 s82, s82, 0x8000
  s_and_b32 s82, s82, 0xfffff
  s_waitcnt vmcnt(11)
  v_mfma_f32_16x16x32_bf16 v[12:15], v[16:19], a[144:147], v[12:15]
  v_and_b32_dpp v16, v49, v8 row_newbcast:6 row_mask:0xf bank_mask:0xf
  v_and_b32_dpp v17, v49, v9 row_newbcast:6 row_mask:0xf bank_mask:0xf
  v_and_b32_dpp v18, v49, v10 row_newbcast:6 row_mask:0xf bank_mask:0xf
  v_and_b32_dpp v19, v49, v11 row_newbcast:6 row_mask:0xf bank_mask:0xf
  s_add_u32 s80, s80, 0x10000
  s_and_b32 s80, s80, 0x1fffff
  buffer_load_dwordx4 v[80:83], v1, s[44:47], s80 offen nt
  buffer_load_dwordx4 v[84:87], v1, s[44:47], s80 offen offset:1024 nt
  buffer_load_dwordx4 v[88:91], v1, s[44:47], s80 offen offset:2048 nt
  buffer_load_dwordx4 a[168:171], v3, s[52:55], s82 offen
  s_add_u32 s82, s82, 0x8000
  s_and_b32 s82, s82, 0xfffff
  s_waitcnt vmcnt(14)
  v_mfma_f32_16x16x32_bf16 v[12:15], v[20:23], a[148:151], v[12:15]
  v_and_b32_dpp v20, v49, v8 row_newbcast:7 row_mask:0xf bank_mask:0xf
  v_and_b32_dpp v21, v49, v9 row_newbcast:7 row_mask:0xf bank_mask:0xf
  v_and_b32_dpp v22, v49, v10 row_newbcast:7 row_mask:0xf bank_mask:0xf
  v_and_b32_dpp v23, v49, v11 row_newbcast:7 row_mask:0xf bank_mask:0xf
  buffer_load_dwordx4 a[172:175], v3, s[52:55], s82 offen
  s_add_u32 s82, s82, 0x8000
  s_and_b32 s82, s82, 0xfffff
  s_waitcnt vmcnt(11)
  v_mfma_f32_16x16x32_bf16 v[12:15], v[16:19], a[152:155], v[12:15]
  v_and_b32_dpp v16, v49, v8 row_newbcast:8 row_mask:0xf bank_mask:0xf
  v_and_b32_dpp v17, v49, v9 row_newbcast:8 row_mask:0xf bank_mask:0xf
  v_and_b32_dpp v18, v49, v10 row_newbcast:8 row_mask:0xf bank_mask:0xf
  v_and_b32_dpp v19, v49, v11 row_newbcast:8 row_mask:0xf bank_mask:0xf
  buffer_load_dwordx4 v[92:95], v1, s[44:47], s80 offen offset:3072 nt
  s_add_u32 s80, s80, 0x10000
  s_and_b32 s80, s80, 0x1fffff
  buffer_load_dwordx4 v[96:99], v1, s[44:47], s80 offen nt
  buffer_load_dwordx4 v[100:103], v1, s[44:47], s80 offen offset:1024 nt
  buffer_load_dwordx4 a[176:179], v3, s[52:55], s82 offen
  s_add_u32 s82, s82, 0x8000
  s_and_b32 s82, s82, 0xfffff
  s_waitcnt vmcnt(14)
  v_mfma_f32_16x16x32_bf16 v[12:15], v[20:23], a[156:159], v[12:15]
  v_and_b32_dpp v20, v49, v8 row_newbcast:9 row_mask:0xf bank_mask:0xf
  v_and_b32_dpp v21, v49, v9 row_newbcast:9 row_mask:0xf bank_mask:0xf
  v_and_b32_dpp v22, v49, v10 row_newbcast:9 row_mask:0xf bank_mask:0xf
  s_branch L_over_0
L_stub_0:
  s_branch L_back_0
L_over_0:
  v_and_b32_dpp v23, v49, v11 row_newbcast:9 row_mask:0xf bank_mask:0xf
  buffer_load_dwordx4 a[180:183], v3, s[52:55], s82 offen
  s_add_u32 s82, s82, 0x8000
  s_and_b32 s82, s82, 0xfffff
  s_waitcnt vmcnt(11)
  v_mfma_f32_16x16x32_bf16 v[12:15], v[16:19], a[160:163], v[12:15]
  v_and_b32_dpp v16, v49, v8 row_newbcast:10 row_mask:0xf bank_mask:0xf
  v_and_b32_dpp v17, v49, v9 row_newbcast:10 row_mask:0xf bank_mask:0xf
  v_and_b32_dpp v18, v49, v10 row_newbcast:10 row_mask:0xf bank_mask:0xf
  v_and_b32_dpp v19, v49, v11 row_newbcast:10 row_mask:0xf bank_mask:0xf
  buffer_load_dwordx4 v[104:107], v1, s[44:47], s80 offen offset:2048 nt
  buffer_load_dwordx4 v[108:111], v1, s[44:47], s80 offen offset:3072 nt
  s_add_u32 s80, s80, 0x10000
  s_and_b32 s80, s80, 0x1fffff
  buffer_load_dwordx4 v[112:115], v1, s[44:47], s80 offen nt
  buffer_load_dwordx4 a[184:187], v3, s[52:55], s82 offen
  s_add_u32 s82, s82, 0x8000
  s_and_b32 s82, s82, 0xfffff
  s_waitcnt vmcnt(14)
  v_mfma_f32_16x16x32_bf16 v[12:15], v[20:23], a[164:167], v[12:15]
  v_and_b32_dpp v20, v49, v8 row_newbcast:11 row_mask:0xf bank_mask:0xf
  v_and_b32_dpp v21, v49, v9 row_newbcast:11 row_mask:0xf bank_mask:0xf
  v_and_b32_dpp v22, v49, v10 row_newbcast:11 row_mask:0xf bank_mask:0xf
  v_and_b32_dpp v23, v49, v11 row_newbcast:11 row_mask:0xf bank_mask:0xf
  buffer_load_dwordx4 a[188:191], v3, s[52:55], s82 offen
  buffer_load_dwordx4 v[116:119], v1, s[44:47], s80 offen offset:1024 nt
  s_waitcnt vmcnt(12)
  v_mfma_f32_16x16x32_bf16 v[12:15], v[16:19], a[168:171], v[12:15]
  v_and_b32_dpp v16, v49, v8 row_newbcast:12 row_mask:0xf bank_mask:0xf
  v_and_b32_dpp v17, v49, v9 row_newbcast:12 row_mask:0xf bank_mask:0xf
  v_and_b32_dpp v18, v49, v10 row_newbcast:12 row_mask:0xf bank_mask:0xf
  v_and_b32_dpp v19, v49, v11 row_newbcast:12 row_mask:0xf bank_mask:0xf
  buffer_load_dwordx4 v[120:123], v1, s[44:47], s80 offen offset:2048 nt
  s_waitcnt vmcnt(12)
  v_mfma_f32_16x16x32_bf16 v[12:15], v[20:23], a[172:175], v[12:15]
  v_and_b32_dpp v20, v49, v8 row_newbcast:13 row_mask:0xf bank_mask:0xf
  v_and_b32_dpp v21, v49, v9 row_newbcast:13 row_mask:0xf bank_mask:0xf
  v_and_b32_dpp v22, v49, v10 row_newbcast:13 row_mask:0xf bank_mask:0xf
  v_and_b32_dpp v23, v49, v11 row_newbcast:13 row_mask:0xf bank_mask:0xf
  buffer_load_dwordx4 v[124:127], v1, s[44:47], s80 offen offset:3072 nt
  s_waitcnt vmcnt(9)
  v_mfma_f32_16x16x32_bf16 v[12:15], v[16:19], a[176:179], v[12:15]
  v_and_b32_dpp v16, v49, v8 row_newbcast:14 row_mask:0xf bank_mask:0xf
  v_and_b32_dpp v17, v49, v9 row_newbcast:14 row_mask:0xf bank_mask:0xf
  v_and_b32_dpp v18, v49, v10 row_newbcast:14 row_mask:0xf bank_mask:0xf
  v_and_b32_dpp v19, v49, v11 row_newbcast:14 row_mask:0xf bank_mask:0xf
  s_add_u32 s81, s81, 0x10000
  s_and_b32 s81, s81, 0x1fffff
  buffer_load_dwordx4 a[0:3], v1, s[48:51], s81 offen nt
  s_waitcnt vmcnt(9)
  v_mfma_f32_16x16x32_bf16 v[12:15], v[20:23], a[180:183], v[12:15]
  v_and_b32_dpp v20, v49, v8 row_newbcast:15 row_mask:0xf bank_mask:0xf
  v_and_b32_dpp v21, v49, v9 row_newbcast:15 row_mask:0xf bank_mask:0xf
  v_and_b32_dpp v22, v49, v10 row_newbcast:15 row_mask:0xf bank_mask:0xf
  v_and_b32_dpp v23, v49, v11 row_newbcast:15 row_mask:0xf bank_mask:0xf
  buffer_load_dwordx4 a[4:7], v1, s[48:51], s81 offen offset:1024 nt
  s_waitcnt vmcnt(6)
  v_mfma_f32_16x16x32_bf16 v[12:15], v[16:19], a[184:187], v[12:15]
  s_nop 1
  buffer_load_dwordx4 a[8:11], v1, s[48:51], s81 offen offset:2048 nt
  s_waitcnt vmcnt(6)
  v_mfma_f32_16x16x32_bf16 v[12:15], v[20:23], a[188:191], v[12:15]
  buffer_load_dwordx4 a[12:15], v1, s[48:51], s81 offen offset:3072 nt
  s_add_u32 s81, s81, 0x10000
  s_and_b32 s81, s81, 0x1fffff
  buffer_load_dwordx4 a[16:19], v1, s[48:51], s81 offen nt
  buffer_load_dwordx4 a[20:23], v1, s[48:51], s81 offen offset:1024 nt
  buffer_load_dwordx4 a[24:27], v1, s[48:51], s81 offen offset:2048 nt
  buffer_load_dwordx4 a[28:31], v1, s[48:51], s81 offen offset:3072 nt
  s_add_u32 s81, s81, 0x10000
  s_and_b32 s81, s81, 0x1fffff
  buffer_load_dwordx4 a[32:35], v1, s[48:51], s81 offen nt
  buffer_load_dwordx4 a[36:39], v1, s[48:51], s81 offen offset:1024 nt
  buffer_load_dwordx4 a[40:43], v1, s[48:51], s81 offen offset:2048 nt
  buffer_load_dwordx4 a[44:47], v1, s[48:51], s81 offen offset:3072 nt
  v_lshrrev_b32 v42, 4, v2
  v_and_b32 v43, 15, v2
  v_lshlrev_b32 v44, 5, v43
  v_lshl_or_b32 v44, v42, 4, v44
  s_lshl_b32 s10, s3, 9
  s_add_u32 s10, s10, 73728
  v_add_u32 v44, s10, v44
  v_lshlrev_b32 v3, 10, v42
  v_lshl_or_b32 v3, v43, 4, v3
  s_mov_b32 s82, 0
  s_nop 3
  s_mov_b32 exec_lo, 0xffffffff
  s_mov_b32 exec_hi, 0x0
  ds_write_b128 v44, v[12:15]
  s_mov_b64 exec, -1
  v_lshlrev_b32 v43, 5, v43
  v_add_u32 v43, 73728, v43
  s_waitcnt lgkmcnt(0)
  s_barrier
  s_add_u32 s26, s26, 1
  s_add_u32 s18, s26, 0
  s_and_b32 s18, s18, 0x3ff
  s_add_u32 s19, s26, 309
  s_and_b32 s19, s19, 0x3ff
  s_add_u32 s20, s26, 183
  s_and_b32 s20, s20, 0x3ff
  s_add_u32 s21, s26, 761
  s_and_b32 s21, s21, 0x3ff
  s_mul_i32 s22, s26, 0x9e37
  s_add_u32 s22, s22, 0x79b8
  s_and_b32 s22, s22, 0xffff
  s_mul_i32 s23, s26, 0x9e3779b1
  ds_read_b128 v[24:27], v43 offset:0
  ds_read_b128 v[28:31], v43 offset:16
  ds_read_b128 v[32:35], v43 offset:512
  ds_read_b128 v[36:39], v43 offset:528
  s_waitcnt lgkmcnt(0)
  v_add_f32 v24, v24, v32
  v_add_f32 v25, v25, v33
  v_add_f32 v26, v26, v34
  v_add_f32 v27, v27, v35
  v_add_f32 v28, v28, v36
  v_add_f32 v29, v29, v37
  v_add_f32 v30, v30, v38
  v_add_f32 v31, v31, v39
  ds_read_b128 v[32:35], v43 offset:1024
  ds_read_b128 v[36:39], v43 offset:1040
  s_waitcnt lgkmcnt(0)
  v_add_f32 v24, v24, v32
  v_add_f32 v25, v25, v33
  v_add_f32 v26, v26, v34
  v_add_f32 v27, v27, v35
  v_add_f32 v28, v28, v36
  v_add_f32 v29, v29, v37
  v_add_f32 v30, v30, v38
  v_add_f32 v31, v31, v39
  ds_read_b128 v[32:35], v43 offset:1536
  ds_read_b128 v[36:39], v43 offset:1552
  s_waitcnt lgkmcnt(0)
  v_add_f32 v24, v24, v32
  v_add_f32 v25, v25, v33
  v_add_f32 v26, v26, v34
  v_add_f32 v27, v27, v35
  v_add_f32 v28, v28, v36
  v_add_f32 v29, v29, v37
  v_add_f32 v30, v30, v38
  v_add_f32 v31, v31, v39
  v_cvt_pk_bf16_f32 v4, v24, v25
  v_cvt_pk_bf16_f32 v5, v26, v27
  v_cvt_pk_bf16_f32 v6, v28, v29
  v_cvt_pk_bf16_f32 v7, v30, v31
L_noflag_3:
  v_mov_b32 v40, 0xff7fffff
  v_mov_b32 v41, 0
  v_mov_b32 v12, 0
  v_mov_b32 v13, 0
  v_mov_b32 v14, 0
  v_mov_b32 v15, 0
  s_mov_b32 s76, s36
  s_mov_b32 s77, s37
  s_mov_b32 s78, 2048
  s_mov_b32 s79, 0x00020000
  v_dot2_f32_bf16 v24, v128, v4, 0
  v_dot2_f32_bf16 v24, v129, v5, v24
  v_dot2_f32_bf16 v24, v130, v6, v24
  v_dot2_f32_bf16 v24, v131, v7, v24
  s_add_u32 s81, s81, 0x10000
  s_and_b32 s81, s81, 0x1fffff
  buffer_load_dwordx4 a[48:51], v1, s[48:51], s81 offen nt
  v_dot2_f32_bf16 v25, v132, v4, 0
  v_dot2_f32_bf16 v25, v133, v5, v25
  v_dot2_f32_bf16 v25, v134, v6, v25
  v_dot2_f32_bf16 v25, v135, v7, v25
  buffer_load_dwordx4 a[52:55], v1, s[48:51], s81 offen offset:1024 nt
  v_dot2_f32_bf16 v26, v136, v4, 0
  v_dot2_f32_bf16 v26, v137, v5, v26
  v_dot2_f32_bf16 v26, v138, v6, v26
  v_dot2_f32_bf16 v26, v139, v7, v26
  buffer_load_dwordx4 a[56:59], v1, s[48:51], s81 offen offset:2048 nt
  buffer_load_dwordx4 a[64:67], v3, s[56:59], s82 offen
  s_add_u32 s82, s82, 4096
  v_dot2_f32_bf16 v27, v140, v4, 0
  v_dot2_f32_bf16 v27, v141, v5, v27
  v_dot2_f32_bf16 v27, v142, v6, v27
  v_dot2_f32_bf16 v27, v143, v7, v27
  buffer_load_dwordx4 a[60:63], v1, s[48:51], s81 offen offset:3072 nt
  v_dot2_f32_bf16 v28, v144, v4, 0
  v_dot2_f32_bf16 v28, v145, v5, v28
  v_dot2_f32_bf16 v28, v146, v6, v28
  v_dot2_f32_bf16 v28, v147, v7, v28
  v_dot2_f32_bf16 v29, v148, v4, 0
  v_dot2_f32_bf16 v29, v149, v5, v29
  v_dot2_f32_bf16 v29, v150, v6, v29
  v_dot2_f32_bf16 v29, v151, v7, v29
  v_dot2_f32_bf16 v30, v152, v4, 0
  v_dot2_f32_bf16 v30, v153, v5, v30
  v_dot2_f32_bf16 v30, v154, v6, v30
  v_dot2_f32_bf16 v30, v155, v7, v30
  buffer_load_dwordx4 a[68:71], v3, s[56:59], s82 offen
  s_add_u32 s82, s82, 4096
  v_dot2_f32_bf16 v31, v156, v4, 0
  v_dot2_f32_bf16 v31, v157, v5, v31
  v_dot2_f32_bf16 v31, v158, v6, v31
  v_dot2_f32_bf16 v31, v159, v7, v31
  v_dot2_f32_bf16 v32, v160, v4, 0
  v_dot2_f32_bf16 v32, v161, v5, v32
  v_dot2_f32_bf16 v32, v162, v6, v32
  v_dot2_f32_bf16 v32, v163, v7, v32
  v_dot2_f32_bf16 v33, v164, v4, 0
  v_dot2_f32_bf16 v33, v165, v5, v33
  v_dot2_f32_bf16 v33, v166, v6, v33
  v_dot2_f32_bf16 v33, v167, v7, v33
  v_dot2_f32_bf16 v34, v168, v4, 0
  v_dot2_f32_bf16 v34, v169, v5, v34
  v_dot2_f32_bf16 v34, v170, v6, v34
  v_dot2_f32_bf16 v34, v171, v7, v34
  buffer_load_dwordx4 a[72:75], v3, s[56:59], s82 offen
  s_add_u32 s82, s82, 4096
  v_dot2_f32_bf16 v35, v172, v4, 0
  v_dot2_f32_bf16 v35, v173, v5, v35
  v_dot2_f32_bf16 v35, v174, v6, v35
  v_dot2_f32_bf16 v35, v175, v7, v35
  v_dot2_f32_bf16 v36, v176, v4, 0
  v_dot2_f32_bf16 v36, v177, v5, v36
  v_dot2_f32_bf16 v36, v178, v6, v36
  v_dot2_f32_bf16 v36, v179, v7, v36
  v_dot2_f32_bf16 v37, v180, v4, 0
  v_dot2_f32_bf16 v37, v181, v5, v37
  v_dot2_f32_bf16 v37, v182, v6, v37
  v_dot2_f32_bf16 v37, v183, v7, v37
  v_dot2_f32_bf16 v38, v184, v4, 0
  v_dot2_f32_bf16 v38, v185, v5, v38
  v_dot2_f32_bf16 v38, v186, v6, v38
  v_dot2_f32_bf16 v38, v187, v7, v38
  buffer_load_dwordx4 a[76:79], v3, s[56:59], s82 offen
  s_add_u32 s82, s82, 4096
  v_dot2_f32_bf16 v39, v188, v4, 0
  v_dot2_f32_bf16 v39, v189, v5, v39
  v_dot2_f32_bf16 v39, v190, v6, v39
  v_dot2_f32_bf16 v39, v191, v7, v39
  s_nop 2
  v_add_f32_dpp v24, v24, v24 row_ror:8 row_mask:0xf bank_mask:0x3
  v_add_f32_dpp v25, v25, v25 row_ror:8 row_mask:0xf bank_mask:0x3
  v_add_f32_dpp v26, v26, v26 row_ror:8 row_mask:0xf bank_mask:0x3
  v_add_f32_dpp v27, v27, v27 row_ror:8 row_mask:0xf bank_mask:0x3
  v_add_f32_dpp v28, v28, v28 row_ror:8 row_mask:0xf bank_mask:0x3
  v_add_f32_dpp v29, v29, v29 row_ror:8 row_mask:0xf bank_mask:0x3
  v_add_f32_dpp v30, v30, v30 row_ror:8 row_mask:0xf bank_mask:0x3
  v_add_f32_dpp v31, v31, v31 row_ror:8 row_mask:0xf bank_mask:0x3
  v_add_f32_dpp v24, v32, v32 row_ror:8 row_mask:0xf bank_mask:0xc
  v_add_f32_dpp v25, v33, v33 row_ror:8 row_mask:0xf bank_mask:0xc
  v_add_f32_dpp v26, v34, v34 row_ror:8 row_mask:0xf bank_mask:0xc
  v_add_f32_dpp v27, v35, v35 row_ror:8 row_mask:0xf bank_mask:0xc
  v_add_f32_dpp v28, v36, v36 row_ror:8 row_mask:0xf bank_mask:0xc
  v_add_f32_dpp v29, v37, v37 row_ror:8 row_mask:0xf bank_mask:0xc
  v_add_f32_dpp v30, v38, v38 row_ror:8 row_mask:0xf bank_mask:0xc
  v_add_f32_dpp v31, v39, v39 row_ror:8 row_mask:0xf bank_mask:0xc
  v_add_f32_dpp v24, v24, v24 row_shl:4 row_mask:0xf bank_mask:0x5
  v_add_f32_dpp v25, v25, v25 row_shl:4 row_mask:0xf bank_mask:0x5
  v_add_f32_dpp v26, v26, v26 row_shl:4 row_mask:0xf bank_mask:0x5
  v_add_f32_dpp v27, v27, v27 row_shl:4 row_mask:0xf bank_mask:0x5
  v_add_f32_dpp v24, v28, v28 row_shr:4 row_mask:0xf bank_mask:0xa
  v_add_f32_dpp v25, v29, v29 row_shr:4 row_mask:0xf bank_mask:0xa
  v_add_f32_dpp v26, v30, v30 row_shr:4 row_mask:0xf bank_mask:0xa
  v_add_f32_dpp v27, v31, v31 row_shr:4 row_mask:0xf bank_mask:0xa
  s_nop 0
  v_add_f32_dpp v42, v24, v24 quad_perm:[2,3,0,1] row_mask:0xf bank_mask:0xf
  v_add_f32_dpp v43, v25, v25 quad_perm:[2,3,0,1] row_mask:0xf bank_mask:0xf
  v_add_f32_dpp v44, v26, v26 quad_perm:[2,3,0,1] row_mask:0xf bank_mask:0xf
  v_add_f32_dpp v45, v27, v27 quad_perm:[2,3,0,1] row_mask:0xf bank_mask:0xf
  v_cndmask_b32_e64 v24, v42, v44, s[88:89]
  v_cndmask_b32_e64 v25, v43, v45, s[88:89]
  s_nop 1
  v_add_f32_dpp v42, v24, v24 quad_perm:[1,0,3,2] row_mask:0xf bank_mask:0xf
  v_add_f32_dpp v43, v25, v25 quad_perm:[1,0,3,2] row_mask:0xf bank_mask:0xf
  v_cndmask_b32_e64 v42, v42, v43, s[86:87]
  v_cvt_pk_bf16_f32 v42, v42, v42
  v_and_b32 v42, 0xffff0000, v42
  v_mul_f32 v42, 0x3db504f3, v42
  v_cvt_pk_bf16_f32 v42, v42, v42
  v_and_b32 v42, 0xffff0000, v42
  v_mov_b32 v43, v42
  s_nop 1
  v_max_f32_dpp v43, v43, v43 row_ror:8 row_mask:0xf bank_mask:0xf
  s_nop 1
  v_max_f32_dpp v43, v43, v43 row_ror:4 row_mask:0xf bank_mask:0xf
  s_nop 1
  v_max_f32_dpp v43, v43, v43 row_ror:2 row_mask:0xf bank_mask:0xf
  s_nop 1
  v_max_f32_dpp v43, v43, v43 row_ror:1 row_mask:0xf bank_mask:0xf
  v_mov_b32 v44, v43
  s_nop 1
  v_permlane16_swap_b32 v43, v44
  s_nop 0
  v_max_f32 v43, v43, v44
  v_mov_b32 v44, v43
  s_nop 1
  v_permlane32_swap_b32 v43, v44
  s_nop 0
  v_max_f32 v43, v43, v44
  v_max_f32 v43, v43, v40
  v_sub_f32 v45, v40, v43
  v_sub_f32 v46, v42, v43
  v_mul_f32 v45, 0x3fb8aa3b, v45
  v_mul_f32 v46, 0x3fb8aa3b, v46
  v_exp_f32 v45, v45
  v_exp_f32 v46, v46
  v_mov_b32 v40, v43
  v_cvt_pk_bf16_f32 v47, v46, v46
  v_fma_f32 v41, v41, v45, v46
  v_mul_f32 v12, v12, v45
  v_mul_f32 v13, v13, v45
  v_mul_f32 v14, v14, v45
  v_mul_f32 v15, v15, v45
  v_and_b32_dpp v16, v47, v8 row_newbcast:0 row_mask:0xf bank_mask:0xf
  v_and_b32_dpp v17, v47, v9 row_newbcast:0 row_mask:0xf bank_mask:0xf
  v_and_b32_dpp v18, v47, v10 row_newbcast:0 row_mask:0xf bank_mask:0xf
  v_and_b32_dpp v19, v47, v11 row_newbcast:0 row_mask:0xf bank_mask:0xf
  v_and_b32_dpp v20, v47, v8 row_newbcast:1 row_mask:0xf bank_mask:0xf
  v_and_b32_dpp v21, v47, v9 row_newbcast:1 row_mask:0xf bank_mask:0xf
  v_and_b32_dpp v22, v47, v10 row_newbcast:1 row_mask:0xf bank_mask:0xf
  v_and_b32_dpp v23, v47, v11 row_newbcast:1 row_mask:0xf bank_mask:0xf
  v_mfma_f32_16x16x32_bf16 v[12:15], v[16:19], a[192:195], v[12:15]
  v_and_b32_dpp v16, v47, v8 row_newbcast:2 row_mask:0xf bank_mask:0xf
  v_and_b32_dpp v17, v47, v9 row_newbcast:2 row_mask:0xf bank_mask:0xf
  v_and_b32_dpp v18, v47, v10 row_newbcast:2 row_mask:0xf bank_mask:0xf
  v_and_b32_dpp v19, v47, v11 row_newbcast:2 row_mask:0xf bank_mask:0xf
  v_mfma_f32_16x16x32_bf16 v[12:15], v[20:23], a[196:199], v[12:15]
  v_and_b32_dpp v20, v47, v8 row_newbcast:3 row_mask:0xf bank_mask:0xf
  v_and_b32_dpp v21, v47, v9 row_newbcast:3 row_mask:0xf bank_mask:0xf
  v_and_b32_dpp v22, v47, v10 row_newbcast:3 row_mask:0xf bank_mask:0xf
  v_and_b32_dpp v23, v47, v11 row_newbcast:3 row_mask:0xf bank_mask:0xf
  v_mfma_f32_16x16x32_bf16 v[12:15], v[16:19], a[200:203], v[12:15]
  v_and_b32_dpp v16, v47, v8 row_newbcast:4 row_mask:0xf bank_mask:0xf
  v_and_b32_dpp v17, v47, v9 row_newbcast:4 row_mask:0xf bank_mask:0xf
  v_and_b32_dpp v18, v47, v10 row_newbcast:4 row_mask:0xf bank_mask:0xf
  v_and_b32_dpp v19, v47, v11 row_newbcast:4 row_mask:0xf bank_mask:0xf
  v_mfma_f32_16x16x32_bf16 v[12:15], v[20:23], a[204:207], v[12:15]
  v_and_b32_dpp v20, v47, v8 row_newbcast:5 row_mask:0xf bank_mask:0xf
  v_and_b32_dpp v21, v47, v9 row_newbcast:5 row_mask:0xf bank_mask:0xf
  v_and_b32_dpp v22, v47, v10 row_newbcast:5 row_mask:0xf bank_mask:0xf
  v_and_b32_dpp v23, v47, v11 row_newbcast:5 row_mask:0xf bank_mask:0xf
  v_mfma_f32_16x16x32_bf16 v[12:15], v[16:19], a[208:211], v[12:15]
  v_and_b32_dpp v16, v47, v8 row_newbcast:6 row_mask:0xf bank_mask:0xf
  v_and_b32_dpp v17, v47, v9 row_newbcast:6 row_mask:0xf bank_mask:0xf
  v_and_b32_dpp v18, v47, v10 row_newbcast:6 row_mask:0xf bank_mask:0xf
  v_and_b32_dpp v19, v47, v11 row_newbcast:6 row_mask:0xf bank_mask:0xf
  v_mfma_f32_16x16x32_bf16 v[12:15], v[20:23], a[212:215], v[12:15]
  v_and_b32_dpp v20, v47, v8 row_newbcast:7 row_mask:0xf bank_mask:0xf
  v_and_b32_dpp v21, v47, v9 row_newbcast:7 row_mask:0xf bank_mask:0xf
  v_and_b32_dpp v22, v47, v10 row_newbcast:7 row_mask:0xf bank_mask:0xf
  v_and_b32_dpp v23, v47, v11 row_newbcast:7 row_mask:0xf bank_mask:0xf
  v_mfma_f32_16x16x32_bf16 v[12:15], v[16:19], a[216:219], v[12:15]
  v_and_b32_dpp v16, v47, v8 row_newbcast:8 row_mask:0xf bank_mask:0xf
  v_and_b32_dpp v17, v47, v9 row_newbcast:8 row_mask:0xf bank_mask:0xf
  v_and_b32_dpp v18, v47, v10 row_newbcast:8 row_mask:0xf bank_mask:0xf
  v_and_b32_dpp v19, v47, v11 row_newbcast:8 row_mask:0xf bank_mask:0xf
  v_mfma_f32_16x16x32_bf16 v[12:15], v[20:23], a[220:223], v[12:15]
  v_and_b32_dpp v20, v47, v8 row_newbcast:9 row_mask:0xf bank_mask:0xf
  v_and_b32_dpp v21, v47, v9 row_newbcast:9 row_mask:0xf bank_mask:0xf
  v_and_b32_dpp v22, v47, v10 row_newbcast:9 row_mask:0xf bank_mask:0xf
  v_and_b32_dpp v23, v47, v11 row_newbcast:9 row_mask:0xf bank_mask:0xf
  v_mfma_f32_16x16x32_bf16 v[12:15], v[16:19], a[224:227], v[12:15]
  buffer_load_dwordx4 a[80:83], v3, s[56:59], s82 offen
  s_add_u32 s82, s82, 4096
  v_and_b32_dpp v16, v47, v8 row_newbcast:10 row_mask:0xf bank_mask:0xf
  v_and_b32_dpp v17, v47, v9 row_newbcast:10 row_mask:0xf bank_mask:0xf
  v_and_b32_dpp v18, v47, v10 row_newbcast:10 row_mask:0xf bank_mask:0xf
  v_and_b32_dpp v19, v47, v11 row_newbcast:10 row_mask:0xf bank_mask:0xf
  v_mfma_f32_16x16x32_bf16 v[12:15], v[20:23], a[228:231], v[12:15]
  v_and_b32_dpp v20, v47, v8 row_newbcast:11 row_mask:0xf bank_mask:0xf
  v_and_b32_dpp v21, v47, v9 row_newbcast:11 row_mask:0xf bank_mask:0xf
  v_and_b32_dpp v22, v47, v10 row_newbcast:11 row_mask:0xf bank_mask:0xf
  v_and_b32_dpp v23, v47, v11 row_newbcast:11 row_mask:0xf bank_mask:0xf
  v_mfma_f32_16x16x32_bf16 v[12:15], v[16:19], a[232:235], v[12:15]
  v_and_b32_dpp v16, v47, v8 row_newbcast:12 row_mask:0xf bank_mask:0xf
  v_and_b32_dpp v17, v47, v9 row_newbcast:12 row_mask:0xf bank_mask:0xf
  v_and_b32_dpp v18, v47, v10 row_newbcast:12 row_mask:0xf bank_mask:0xf
  v_and_b32_dpp v19, v47, v11 row_newbcast:12 row_mask:0xf bank_mask:0xf
  v_mfma_f32_16x16x32_bf16 v[12:15], v[20:23], a[236:239], v[12:15]
  v_and_b32_dpp v20, v47, v8 row_newbcast:13 row_mask:0xf bank_mask:0xf
  v_and_b32_dpp v21, v47, v9 row_newbcast:13 row_mask:0xf bank_mask:0xf
  v_and_b32_dpp v22, v47, v10 row_newbcast:13 row_mask:0xf bank_mask:0xf
  v_and_b32_dpp v23, v47, v11 row_newbcast:13 row_mask:0xf bank_mask:0xf
  v_mfma_f32_16x16x32_bf16 v[12:15], v[16:19], a[240:243], v[12:15]
  v_and_b32_dpp v16, v47, v8 row_newbcast:14 row_mask:0xf bank_mask:0xf
  v_and_b32_dpp v17, v47, v9 row_newbcast:14 row_mask:0xf bank_mask:0xf
  v_and_b32_dpp v18, v47, v10 row_newbcast:14 row_mask:0xf bank_mask:0xf
  v_and_b32_dpp v19, v47, v11 row_newbcast:14 row_mask:0xf bank_mask:0xf
  v_mfma_f32_16x16x32_bf16 v[12:15], v[20:23], a[244:247], v[12:15]
  v_and_b32_dpp v20, v47, v8 row_newbcast:15 row_mask:0xf bank_mask:0xf
  v_and_b32_dpp v21, v47, v9 row_newbcast:15 row_mask:0xf bank_mask:0xf
  v_and_b32_dpp v22, v47, v10 row_newbcast:15 row_mask:0xf bank_mask:0xf
  v_and_b32_dpp v23, v47, v11 row_newbcast:15 row_mask:0xf bank_mask:0xf
  v_mfma_f32_16x16x32_bf16 v[12:15], v[16:19], a[248:251], v[12:15]
  s_nop 1
  v_mfma_f32_16x16x32_bf16 v[12:15], v[20:23], a[252:255], v[12:15]
  v_dot2_f32_bf16 v24, v64, v4, 0
  v_dot2_f32_bf16 v24, v65, v5, v24
  v_dot2_f32_bf16 v24, v66, v6, v24
  v_dot2_f32_bf16 v24, v67, v7, v24
  s_add_u32 s80, s80, 0x10000
  s_and_b32 s80, s80, 0x1fffff
  s_waitcnt vmcnt(5)
  buffer_load_dwordx4 v[64:67], v1, s[44:47], s80 offen nt
  v_dot2_f32_bf16 v25, v68, v4, 0
  v_dot2_f32_bf16 v25, v69, v5, v25
  v_dot2_f32_bf16 v25, v70, v6, v25
  v_dot2_f32_bf16 v25, v71, v7, v25
  s_waitcnt vmcnt(5)
  buffer_load_dwordx4 v[68:71], v1, s[44:47], s80 offen offset:1024 nt
  v_dot2_f32_bf16 v26, v72, v4, 0
  v_dot2_f32_bf16 v26, v73, v5, v26
  v_dot2_f32_bf16 v26, v74, v6, v26
  v_dot2_f32_bf16 v26, v75, v7, v26
  s_waitcnt vmcnt(5)
  buffer_load_dwordx4 v[72:75], v1, s[44:47], s80 offen offset:2048 nt
  buffer_load_dwordx4 a[84:87], v3, s[56:59], s82 offen
  s_add_u32 s82, s82, 4096
  v_dot2_f32_bf16 v27, v76, v4, 0
  v_dot2_f32_bf16 v27, v77, v5, v27
  v_dot2_f32_bf16 v27, v78, v6, v27
  v_dot2_f32_bf16 v27, v79, v7, v27
  s_waitcnt vmcnt(5)
  buffer_load_dwordx4 v[76:79], v1, s[44:47], s80 offen offset:3072 nt
  v_dot2_f32_bf16 v28, v80, v4, 0
  v_dot2_f32_bf16 v28, v81, v5, v28
  v_dot2_f32_bf16 v28, v82, v6, v28
  v_dot2_f32_bf16 v28, v83, v7, v28
  s_add_u32 s80, s80, 0x10000
  s_and_b32 s80, s80, 0x1fffff
  s_waitcnt vmcnt(5)
  buffer_load_dwordx4 v[80:83], v1, s[44:47], s80 offen nt
  v_dot2_f32_bf16 v29, v84, v4, 0
  v_dot2_f32_bf16 v29, v85, v5, v29
  v_dot2_f32_bf16 v29, v86, v6, v29
  v_dot2_f32_bf16 v29, v87, v7, v29
  s_waitcnt vmcnt(5)
  buffer_load_dwordx4 v[84:87], v1, s[44:47], s80 offen offset:1024 nt
  v_dot2_f32_bf16 v30, v88, v4, 0
  v_dot2_f32_bf16 v30, v89, v5, v30
  v_dot2_f32_bf16 v30, v90, v6, v30
  v_dot2_f32_bf16 v30, v91, v7, v30
  s_waitcnt vmcnt(5)
  buffer_load_dwordx4 v[88:91], v1, s[44:47], s80 offen offset:2048 nt
  buffer_load_dwordx4 a[88:91], v3, s[56:59], s82 offen
  s_add_u32 s82, s82, 4096
  v_dot2_f32_bf16 v31, v92, v4, 0
  v_dot2_f32_bf16 v31, v93, v5, v31
  v_dot2_f32_bf16 v31, v94, v6, v31
  v_dot2_f32_bf16 v31, v95, v7, v31
  s_waitcnt vmcnt(5)
  buffer_load_dwordx4 v[92:95], v1, s[44:47], s80 offen offset:3072 nt
  v_dot2_f32_bf16 v32, v96, v4, 0
  v_dot2_f32_bf16 v32, v97, v5, v32
  v_dot2_f32_bf16 v32, v98, v6, v32
  v_dot2_f32_bf16 v32, v99, v7, v32
  s_add_u32 s80, s80, 0x10000
  s_and_b32 s80, s80, 0x1fffff
  s_waitcnt vmcnt(5)
  buffer_load_dwordx4 v[96:99], v1, s[44:47], s80 offen nt
  v_dot2_f32_bf16 v33, v100, v4, 0
  v_dot2_f32_bf16 v33, v101, v5, v33
  v_dot2_f32_bf16 v33, v102, v6, v33
  v_dot2_f32_bf16 v33, v103, v7, v33
  s_waitcnt vmcnt(5)
  buffer_load_dwordx4 v[100:103], v1, s[44:47], s80 offen offset:1024 nt
  v_dot2_f32_bf16 v34, v104, v4, 0
  v_dot2_f32_bf16 v34, v105, v5, v34
  v_dot2_f32_bf16 v34, v106, v6, v34
  v_dot2_f32_bf16 v34, v107, v7, v34
  s_waitcnt vmcnt(5)
  buffer_load_dwordx4 v[104:107], v1, s[44:47], s80 offen offset:2048 nt
  buffer_load_dwordx4 a[92:95], v3, s[56:59], s82 offen
  s_add_u32 s82, s82, 4096
  v_dot2_f32_bf16 v35, v108, v4, 0
  v_dot2_f32_bf16 v35, v109, v5, v35
  v_dot2_f32_bf16 v35, v110, v6, v35
  v_dot2_f32_bf16 v35, v111, v7, v35
  s_waitcnt vmcnt(5)
  buffer_load_dwordx4 v[108:111], v1, s[44:47], s80 offen offset:3072 nt
  v_dot2_f32_bf16 v36, v112, v4, 0
  v_dot2_f32_bf16 v36, v113, v5, v36
  v_dot2_f32_bf16 v36, v114, v6, v36
  v_dot2_f32_bf16 v36, v115, v7, v36
  s_add_u32 s80, s80, 0x10000
  s_and_b32 s80, s80, 0x1fffff
  s_waitcnt vmcnt(5)
  buffer_load_dwordx4 v[112:115], v1, s[44:47], s80 offen nt
  v_dot2_f32_bf16 v37, v116, v4, 0
  v_dot2_f32_bf16 v37, v117, v5, v37
  v_dot2_f32_bf16 v37, v118, v6, v37
  v_dot2_f32_bf16 v37, v119, v7, v37
  s_waitcnt vmcnt(5)
  buffer_load_dwordx4 v[116:119], v1, s[44:47], s80 offen offset:1024 nt
  v_dot2_f32_bf16 v38, v120, v4, 0
  v_dot2_f32_bf16 v38, v121, v5, v38
  v_dot2_f32_bf16 v38, v122, v6, v38
  v_dot2_f32_bf16 v38, v123, v7, v38
  s_waitcnt vmcnt(5)
  buffer_load_dwordx4 v[120:123], v1, s[44:47], s80 offen offset:2048 nt
  buffer_load_dwordx4 a[96:99], v3, s[56:59], s82 offen
  s_add_u32 s82, s82, 4096
  v_dot2_f32_bf16 v39, v124, v4, 0
  v_dot2_f32_bf16 v39, v125, v5, v39
  v_dot2_f32_bf16 v39, v126, v6, v39
  v_dot2_f32_bf16 v39, v127, v7, v39
  s_waitcnt vmcnt(5)
  buffer_load_dwordx4 v[124:127], v1, s[44:47], s80 offen offset:3072 nt
  s_nop 2
  v_add_f32_dpp v24, v24, v24 row_ror:8 row_mask:0xf bank_mask:0x3
  v_add_f32_dpp v25, v25, v25 row_ror:8 row_mask:0xf bank_mask:0x3
  v_add_f32_dpp v26, v26, v26 row_ror:8 row_mask:0xf bank_mask:0x3
  v_add_f32_dpp v27, v27, v27 row_ror:8 row_mask:0xf bank_mask:0x3
  v_add_f32_dpp v28, v28, v28 row_ror:8 row_mask:0xf bank_mask:0x3
  v_add_f32_dpp v29, v29, v29 row_ror:8 row_mask:0xf bank_mask:0x3
  v_add_f32_dpp v30, v30, v30 row_ror:8 row_mask:0xf bank_mask:0x3
  v_add_f32_dpp v31, v31, v31 row_ror:8 row_mask:0xf bank_mask:0x3
  v_add_f32_dpp v24, v32, v32 row_ror:8 row_mask:0xf bank_mask:0xc
  v_add_f32_dpp v25, v33, v33 row_ror:8 row_mask:0xf bank_mask:0xc
  v_add_f32_dpp v26, v34, v34 row_ror:8 row_mask:0xf bank_mask:0xc
  v_add_f32_dpp v27, v35, v35 row_ror:8 row_mask:0xf bank_mask:0xc
  v_add_f32_dpp v28, v36, v36 row_ror:8 row_mask:0xf bank_mask:0xc
  v_add_f32_dpp v29, v37, v37 row_ror:8 row_mask:0xf bank_mask:0xc
  v_add_f32_dpp v30, v38, v38 row_ror:8 row_mask:0xf bank_mask:0xc
  v_add_f32_dpp v31, v39, v39 row_ror:8 row_mask:0xf bank_mask:0xc
  v_add_f32_dpp v24, v24, v24 row_shl:4 row_mask:0xf bank_mask:0x5
  v_add_f32_dpp v25, v25, v25 row_shl:4 row_mask:0xf bank_mask:0x5
  v_add_f32_dpp v26, v26, v26 row_shl:4 row_mask:0xf bank_mask:0x5
  v_add_f32_dpp v27, v27, v27 row_shl:4 row_mask:0xf bank_mask:0x5
  v_add_f32_dpp v24, v28, v28 row_shr:4 row_mask:0xf bank_mask:0xa
  v_add_f32_dpp v25, v29, v29 row_shr:4 row_mask:0xf bank_mask:0xa
  v_add_f32_dpp v26, v30, v30 row_shr:4 row_mask:0xf bank_mask:0xa
  v_add_f32_dpp v27, v31, v31 row_shr:4 row_mask:0xf bank_mask:0xa
  s_nop 0
  v_add_f32_dpp v42, v24, v24 quad_perm:[2,3,0,1] row_mask:0xf bank_mask:0xf
  v_add_f32_dpp v43, v25, v25 quad_perm:[2,3,0,1] row_mask:0xf bank_mask:0xf
  v_add_f32_dpp v44, v26, v26 quad_perm:[2,3,0,1] row_mask:0xf bank_mask:0xf
  v_add_f32_dpp v45, v27, v27 quad_perm:[2,3,0,1] row_mask:0xf bank_mask:0xf
  v_cndmask_b32_e64 v24, v42, v44, s[88:89]
  v_cndmask_b32_e64 v25, v43, v45, s[88:89]
  s_nop 1
  v_add_f32_dpp v42, v24, v24 quad_perm:[1,0,3,2] row_mask:0xf bank_mask:0xf
  v_add_f32_dpp v43, v25, v25 quad_perm:[1,0,3,2] row_mask:0xf bank_mask:0xf
  v_cndmask_b32_e64 v42, v42, v43, s[86:87]
  v_cvt_pk_bf16_f32 v42, v42, v42
  v_and_b32 v42, 0xffff0000, v42
  v_mul_f32 v42, 0x3db504f3, v42
  v_cvt_pk_bf16_f32 v42, v42, v42
  v_and_b32 v42, 0xffff0000, v42
  v_mov_b32 v43, v42
  s_nop 1
  v_max_f32_dpp v43, v43, v43 row_ror:8 row_mask:0xf bank_mask:0xf
  s_nop 1
  v_max_f32_dpp v43, v43, v43 row_ror:4 row_mask:0xf bank_mask:0xf
  s_nop 1
  v_max_f32_dpp v43, v43, v43 row_ror:2 row_mask:0xf bank_mask:0xf
  s_nop 1
  v_max_f32_dpp v43, v43, v43 row_ror:1 row_mask:0xf bank_mask:0xf
  v_mov_b32 v44, v43
  s_nop 1
  v_permlane16_swap_b32 v43, v44
  s_nop 0
  v_max_f32 v43, v43, v44
  v_mov_b32 v44, v43
  s_nop 1
  v_permlane32_swap_b32 v43, v44
  s_nop 0
  v_max_f32 v43, v43, v44
  v_max_f32 v43, v43, v40
  v_sub_f32 v45, v40, v43
  v_sub_f32 v46, v42, v43
  v_mul_f32 v45, 0x3fb8aa3b, v45
  v_mul_f32 v46, 0x3fb8aa3b, v46
  v_exp_f32 v45, v45
  v_exp_f32 v46, v46
  v_mov_b32 v40, v43
  v_cvt_pk_bf16_f32 v47, v46, v46
  v_fma_f32 v41, v41, v45, v46
  v_mul_f32 v12, v12, v45
  v_mul_f32 v13, v13, v45
  v_mul_f32 v14, v14, v45
  v_mul_f32 v15, v15, v45
  s_branch L_over_1
L_stub_1:
  s_branch L_back_0
L_over_1:
  v_and_b32_dpp v16, v47, v8 row_newbcast:0 row_mask:0xf bank_mask:0xf
  v_and_b32_dpp v17, v47, v9 row_newbcast:0 row_mask:0xf bank_mask:0xf
  v_and_b32_dpp v18, v47, v10 row_newbcast:0 row_mask:0xf bank_mask:0xf
  v_and_b32_dpp v19, v47, v11 row_newbcast:0 row_mask:0xf bank_mask:0xf
  v_and_b32_dpp v20, v47, v8 row_newbcast:1 row_mask:0xf bank_mask:0xf
  v_and_b32_dpp v21, v47, v9 row_newbcast:1 row_mask:0xf bank_mask:0xf
  v_and_b32_dpp v22, v47, v10 row_newbcast:1 row_mask:0xf bank_mask:0xf
  v_and_b32_dpp v23, v47, v11 row_newbcast:1 row_mask:0xf bank_mask:0xf
  v_mfma_f32_16x16x32_bf16 v[12:15], v[16:19], a[0:3], v[12:15]
  s_add_u32 s81, s81, 0x10000
  s_and_b32 s81, s81, 0x1fffff
  s_waitcnt vmcnt(5)
  buffer_load_dwordx4 a[0:3], v1, s[48:51], s81 offen nt
  v_and_b32_dpp v16, v47, v8 row_newbcast:2 row_mask:0xf bank_mask:0xf
  v_and_b32_dpp v17, v47, v9 row_newbcast:2 row_mask:0xf bank_mask:0xf
  v_and_b32_dpp v18, v47, v10 row_newbcast:2 row_mask:0xf bank_mask:0xf
  v_and_b32_dpp v19, v47, v11 row_newbcast:2 row_mask:0xf bank_mask:0xf
  v_mfma_f32_16x16x32_bf16 v[12:15], v[20:23], a[4:7], v[12:15]
  s_waitcnt vmcnt(5)
  buffer_load_dwordx4 a[4:7], v1, s[48:51], s81 offen offset:1024 nt
  v_and_b32_dpp v20, v47, v8 row_newbcast:3 row_mask:0xf bank_mask:0xf
  v_and_b32_dpp v21, v47, v9 row_newbcast:3 row_mask:0xf bank_mask:0xf
  v_and_b32_dpp v22, v47, v10 row_newbcast:3 row_mask:0xf bank_mask:0xf
  v_and_b32_dpp v23, v47, v11 row_newbcast:3 row_mask:0xf bank_mask:0xf
  v_mfma_f32_16x16x32_bf16 v[12:15], v[16:19], a[8:11], v[12:15]
  s_waitcnt vmcnt(5)
  buffer_load_dwordx4 a[8:11], v1, s[48:51], s81 offen offset:2048 nt
  v_and_b32_dpp v16, v47, v8 row_newbcast:4 row_mask:0xf bank_mask:0xf
  v_and_b32_dpp v17, v47, v9 row_newbcast:4 row_mask:0xf bank_mask:0xf
  v_and_b32_dpp v18, v47, v10 row_newbcast:4 row_mask:0xf bank_mask:0xf
  v_and_b32_dpp v19, v47, v11 row_newbcast:4 row_mask:0xf bank_mask:0xf
  v_mfma_f32_16x16x32_bf16 v[12:15], v[20:23], a[12:15], v[12:15]
  s_waitcnt vmcnt(5)
  buffer_load_dwordx4 a[12:15], v1, s[48:51], s81 offen offset:3072 nt
  v_and_b32_dpp v20, v47, v8 row_newbcast:5 row_mask:0xf bank_mask:0xf
  v_and_b32_dpp v21, v47, v9 row_newbcast:5 row_mask:0xf bank_mask:0xf
  v_and_b32_dpp v22, v47, v10 row_newbcast:5 row_mask:0xf bank_mask:0xf
  v_and_b32_dpp v23, v47, v11 row_newbcast:5 row_mask:0xf bank_mask:0xf
  v_mfma_f32_16x16x32_bf16 v[12:15], v[16:19], a[16:19], v[12:15]
  s_add_u32 s81, s81, 0x10000
  s_and_b32 s81, s81, 0x1fffff
  s_waitcnt vmcnt(5)
  buffer_load_dwordx4 a[16:19], v1, s[48:51], s81 offen nt
  v_and_b32_dpp v16, v47, v8 row_newbcast:6 row_mask:0xf bank_mask:0xf
  v_and_b32_dpp v17, v47, v9 row_newbcast:6 row_mask:0xf bank_mask:0xf
  v_and_b32_dpp v18, v47, v10 row_newbcast:6 row_mask:0xf bank_mask:0xf
  v_and_b32_dpp v19, v47, v11 row_newbcast:6 row_mask:0xf bank_mask:0xf
  v_mfma_f32_16x16x32_bf16 v[12:15], v[20:23], a[20:23], v[12:15]
  s_waitcnt vmcnt(5)
  buffer_load_dwordx4 a[20:23], v1, s[48:51], s81 offen offset:1024 nt
  v_and_b32_dpp v20, v47, v8 row_newbcast:7 row_mask:0xf bank_mask:0xf
  v_and_b32_dpp v21, v47, v9 row_newbcast:7 row_mask:0xf bank_mask:0xf
  v_and_b32_dpp v22, v47, v10 row_newbcast:7 row_mask:0xf bank_mask:0xf
  v_and_b32_dpp v23, v47, v11 row_newbcast:7 row_mask:0xf bank_mask:0xf
  v_mfma_f32_16x16x32_bf16 v[12:15], v[16:19], a[24:27], v[12:15]
  s_waitcnt vmcnt(5)
  buffer_load_dwordx4 a[24:27], v1, s[48:51], s81 offen offset:2048 nt
  v_and_b32_dpp v16, v47, v8 row_newbcast:8 row_mask:0xf bank_mask:0xf
  v_and_b32_dpp v17, v47, v9 row_newbcast:8 row_mask:0xf bank_mask:0xf
  v_and_b32_dpp v18, v47, v10 row_newbcast:8 row_mask:0xf bank_mask:0xf
  v_and_b32_dpp v19, v47, v11 row_newbcast:8 row_mask:0xf bank_mask:0xf
  v_mfma_f32_16x16x32_bf16 v[12:15], v[20:23], a[28:31], v[12:15]
  s_waitcnt vmcnt(5)
  buffer_load_dwordx4 a[28:31], v1, s[48:51], s81 offen offset:3072 nt
  v_and_b32_dpp v20, v47, v8 row_newbcast:9 row_mask:0xf bank_mask:0xf
  v_and_b32_dpp v21, v47, v9 row_newbcast:9 row_mask:0xf bank_mask:0xf
  v_and_b32_dpp v22, v47, v10 row_newbcast:9 row_mask:0xf bank_mask:0xf
  v_and_b32_dpp v23, v47, v11 row_newbcast:9 row_mask:0xf bank_mask:0xf
  v_mfma_f32_16x16x32_bf16 v[12:15], v[16:19], a[32:35], v[12:15]
  s_add_u32 s81, s81, 0x10000
  s_and_b32 s81, s81, 0x1fffff
  s_waitcnt vmcnt(5)
  buffer_load_dwordx4 a[32:35], v1, s[48:51], s81 offen nt
  buffer_load_dwordx4 a[100:103], v3, s[56:59], s82 offen
  s_add_u32 s82, s82, 4096
  v_and_b32_dpp v16, v47, v8 row_newbcast:10 row_mask:0xf bank_mask:0xf
  v_and_b32_dpp v17, v47, v9 row_newbcast:10 row_mask:0xf bank_mask:0xf
  v_and_b32_dpp v18, v47, v10 row_newbcast:10 row_mask:0xf bank_mask:0xf
  v_and_b32_dpp v19, v47, v11 row_newbcast:10 row_mask:0xf bank_mask:0xf
  v_mfma_f32_16x16x32_bf16 v[12:15], v[20:23], a[36:39], v[12:15]
  s_waitcnt vmcnt(5)
  buffer_load_dwordx4 a[36:39], v1, s[48:51], s81 offen offset:1024 nt
  v_and_b32_dpp v20, v47, v8 row_newbcast:11 row_mask:0xf bank_mask:0xf
  v_and_b32_dpp v21, v47, v9 row_newbcast:11 row_mask:0xf bank_mask:0xf
  v_and_b32_dpp v22, v47, v10 row_newbcast:11 row_mask:0xf bank_mask:0xf
  v_and_b32_dpp v23, v47, v11 row_newbcast:11 row_mask:0xf bank_mask:0xf
  v_mfma_f32_16x16x32_bf16 v[12:15], v[16:19], a[40:43], v[12:15]
  s_waitcnt vmcnt(5)
  buffer_load_dwordx4 a[40:43], v1, s[48:51], s81 offen offset:2048 nt
  v_and_b32_dpp v16, v47, v8 row_newbcast:12 row_mask:0xf bank_mask:0xf
  v_and_b32_dpp v17, v47, v9 row_newbcast:12 row_mask:0xf bank_mask:0xf
  v_and_b32_dpp v18, v47, v10 row_newbcast:12 row_mask:0xf bank_mask:0xf
  v_and_b32_dpp v19, v47, v11 row_newbcast:12 row_mask:0xf bank_mask:0xf
  v_mfma_f32_16x16x32_bf16 v[12:15], v[20:23], a[44:47], v[12:15]
  s_waitcnt vmcnt(5)
  buffer_load_dwordx4 a[44:47], v1, s[48:51], s81 offen offset:3072 nt
  v_and_b32_dpp v20, v47, v8 row_newbcast:13 row_mask:0xf bank_mask:0xf
  v_and_b32_dpp v21, v47, v9 row_newbcast:13 row_mask:0xf bank_mask:0xf
  v_and_b32_dpp v22, v47, v10 row_newbcast:13 row_mask:0xf bank_mask:0xf
  v_and_b32_dpp v23, v47, v11 row_newbcast:13 row_mask:0xf bank_mask:0xf
  v_mfma_f32_16x16x32_bf16 v[12:15], v[16:19], a[48:51], v[12:15]
  s_add_u32 s81, s81, 0x10000
  s_and_b32 s81, s81, 0x1fffff
  s_waitcnt vmcnt(5)
  buffer_load_dwordx4 a[48:51], v1, s[48:51], s81 offen nt
  v_and_b32_dpp v16, v47, v8 row_newbcast:14 row_mask:0xf bank_mask:0xf
  v_and_b32_dpp v17, v47, v9 row_newbcast:14 row_mask:0xf bank_mask:0xf
  v_and_b32_dpp v18, v47, v10 row_newbcast:14 row_mask:0xf bank_mask:0xf
  v_and_b32_dpp v19, v47, v11 row_newbcast:14 row_mask:0xf bank_mask:0xf
  v_mfma_f32_16x16x32_bf16 v[12:15], v[20:23], a[52:55], v[12:15]
  s_waitcnt vmcnt(5)
  buffer_load_dwordx4 a[52:55], v1, s[48:51], s81 offen offset:1024 nt
  v_and_b32_dpp v20, v47, v8 row_newbcast:15 row_mask:0xf bank_mask:0xf
  v_and_b32_dpp v21, v47, v9 row_newbcast:15 row_mask:0xf bank_mask:0xf
  v_and_b32_dpp v22, v47, v10 row_newbcast:15 row_mask:0xf bank_mask:0xf
  v_and_b32_dpp v23, v47, v11 row_newbcast:15 row_mask:0xf bank_mask:0xf
  v_mfma_f32_16x16x32_bf16 v[12:15], v[16:19], a[56:59], v[12:15]
  s_waitcnt vmcnt(5)
  buffer_load_dwordx4 a[56:59], v1, s[48:51], s81 offen offset:2048 nt
  s_nop 1
  v_mfma_f32_16x16x32_bf16 v[12:15], v[20:23], a[60:63], v[12:15]
  s_waitcnt vmcnt(5)
  buffer_load_dwordx4 a[60:63], v1, s[48:51], s81 offen offset:3072 nt
  v_dot2_f32_bf16 v24, v64, v4, 0
  v_dot2_f32_bf16 v24, v65, v5, v24
  v_dot2_f32_bf16 v24, v66, v6, v24
  v_dot2_f32_bf16 v24, v67, v7, v24
  s_add_u32 s80, s80, 0x10000
  s_and_b32 s80, s80, 0x1fffff
  s_waitcnt vmcnt(5)
  buffer_load_dwordx4 v[64:67], v1, s[44:47], s80 offen nt
  v_dot2_f32_bf16 v25, v68, v4, 0
  v_dot2_f32_bf16 v25, v69, v5, v25
  v_dot2_f32_bf16 v25, v70, v6, v25
  v_dot2_f32_bf16 v25, v71, v7, v25
  s_waitcnt vmcnt(5)
  buffer_load_dwordx4 v[68:71], v1, s[44:47], s80 offen offset:1024 nt
  v_dot2_f32_bf16 v26, v72, v4, 0
  v_dot2_f32_bf16 v26, v73, v5, v26
  v_dot2_f32_bf16 v26, v74, v6, v26
  v_dot2_f32_bf16 v26, v75, v7, v26
  s_waitcnt vmcnt(5)
  buffer_load_dwordx4 v[72:75], v1, s[44:47], s80 offen offset:2048 nt
  buffer_load_dwordx4 a[104:107], v3, s[56:59], s82 offen
  s_add_u32 s82, s82, 4096
  v_dot2_f32_bf16 v27, v76, v4, 0
  v_dot2_f32_bf16 v27, v77, v5, v27
  v_dot2_f32_bf16 v27, v78, v6, v27
  v_dot2_f32_bf16 v27, v79, v7, v27
  s_waitcnt vmcnt(5)
  buffer_load_dwordx4 v[76:79], v1, s[44:47], s80 offen offset:3072 nt
  v_dot2_f32_bf16 v28, v80, v4, 0
  v_dot2_f32_bf16 v28, v81, v5, v28
  v_dot2_f32_bf16 v28, v82, v6, v28
  v_dot2_f32_bf16 v28, v83, v7, v28
  s_add_u32 s80, s80, 0x10000
  s_and_b32 s80, s80, 0x1fffff
  s_waitcnt vmcnt(5)
  buffer_load_dwordx4 v[80:83], v1, s[44:47], s80 offen nt
  v_dot2_f32_bf16 v29, v84, v4, 0
  v_dot2_f32_bf16 v29, v85, v5, v29
  v_dot2_f32_bf16 v29, v86, v6, v29
  v_dot2_f32_bf16 v29, v87, v7, v29
  s_waitcnt vmcnt(5)
  buffer_load_dwordx4 v[84:87], v1, s[44:47], s80 offen offset:1024 nt
  v_dot2_f32_bf16 v30, v88, v4, 0
  v_dot2_f32_bf16 v30, v89, v5, v30
  v_dot2_f32_bf16 v30, v90, v6, v30
  v_dot2_f32_bf16 v30, v91, v7, v30
  s_waitcnt vmcnt(5)
  buffer_load_dwordx4 v[88:91], v1, s[44:47], s80 offen offset:2048 nt
  buffer_load_dwordx4 a[108:111], v3, s[56:59], s82 offen
  s_add_u32 s82, s82, 4096
  v_dot2_f32_bf16 v31, v92, v4, 0
  v_dot2_f32_bf16 v31, v93, v5, v31
  v_dot2_f32_bf16 v31, v94, v6, v31
  v_dot2_f32_bf16 v31, v95, v7, v31
  s_waitcnt vmcnt(5)
  buffer_load_dwordx4 v[92:95], v1, s[44:47], s80 offen offset:3072 nt
  v_dot2_f32_bf16 v32, v96, v4, 0
  v_dot2_f32_bf16 v32, v97, v5, v32
  v_dot2_f32_bf16 v32, v98, v6, v32
  v_dot2_f32_bf16 v32, v99, v7, v32
  s_add_u32 s80, s80, 0x10000
  s_and_b32 s80, s80, 0x1fffff
  s_waitcnt vmcnt(5)
  buffer_load_dwordx4 v[96:99], v1, s[44:47], s80 offen nt
  v_dot2_f32_bf16 v33, v100, v4, 0
  v_dot2_f32_bf16 v33, v101, v5, v33
  v_dot2_f32_bf16 v33, v102, v6, v33
  v_dot2_f32_bf16 v33, v103, v7, v33
  s_waitcnt vmcnt(5)
  buffer_load_dwordx4 v[100:103], v1, s[44:47], s80 offen offset:1024 nt
  v_dot2_f32_bf16 v34, v104, v4, 0
  v_dot2_f32_bf16 v34, v105, v5, v34
  v_dot2_f32_bf16 v34, v106, v6, v34
  v_dot2_f32_bf16 v34, v107, v7, v34
  s_waitcnt vmcnt(5)
  buffer_load_dwordx4 v[104:107], v1, s[44:47], s80 offen offset:2048 nt
  buffer_load_dwordx4 a[112:115], v3, s[56:59], s82 offen
  s_add_u32 s82, s82, 4096
  v_dot2_f32_bf16 v35, v108, v4, 0
  v_dot2_f32_bf16 v35, v109, v5, v35
  v_dot2_f32_bf16 v35, v110, v6, v35
  v_dot2_f32_bf16 v35, v111, v7, v35
  s_waitcnt vmcnt(5)
  buffer_load_dwordx4 v[108:111], v1, s[44:47], s80 offen offset:3072 nt
  v_dot2_f32_bf16 v36, v112, v4, 0
  v_dot2_f32_bf16 v36, v113, v5, v36
  v_dot2_f32_bf16 v36, v114, v6, v36
  v_dot2_f32_bf16 v36, v115, v7, v36
  s_add_u32 s80, s80, 0x10000
  s_and_b32 s80, s80, 0x1fffff
  s_waitcnt vmcnt(5)
  buffer_load_dwordx4 v[112:115], v1, s[44:47], s80 offen nt
  v_dot2_f32_bf16 v37, v116, v4, 0
  v_dot2_f32_bf16 v37, v117, v5, v37
  v_dot2_f32_bf16 v37, v118, v6, v37
  v_dot2_f32_bf16 v37, v119, v7, v37
  s_waitcnt vmcnt(5)
  buffer_load_dwordx4 v[116:119], v1, s[44:47], s80 offen offset:1024 nt
  v_dot2_f32_bf16 v38, v120, v4, 0
  v_dot2_f32_bf16 v38, v121, v5, v38
  v_dot2_f32_bf16 v38, v122, v6, v38
  v_dot2_f32_bf16 v38, v123, v7, v38
  s_waitcnt vmcnt(5)
  buffer_load_dwordx4 v[120:123], v1, s[44:47], s80 offen offset:2048 nt
  buffer_load_dwordx4 a[116:119], v3, s[56:59], s82 offen
  s_add_u32 s82, s82, 4096
  v_dot2_f32_bf16 v39, v124, v4, 0
  v_dot2_f32_bf16 v39, v125, v5, v39
  v_dot2_f32_bf16 v39, v126, v6, v39
  v_dot2_f32_bf16 v39, v127, v7, v39
  s_waitcnt vmcnt(5)
  buffer_load_dwordx4 v[124:127], v1, s[44:47], s80 offen offset:3072 nt
  s_nop 2
  v_add_f32_dpp v24, v24, v24 row_ror:8 row_mask:0xf bank_mask:0x3
  v_add_f32_dpp v25, v25, v25 row_ror:8 row_mask:0xf bank_mask:0x3
  v_add_f32_dpp v26, v26, v26 row_ror:8 row_mask:0xf bank_mask:0x3
  v_add_f32_dpp v27, v27, v27 row_ror:8 row_mask:0xf bank_mask:0x3
  v_add_f32_dpp v28, v28, v28 row_ror:8 row_mask:0xf bank_mask:0x3
  v_add_f32_dpp v29, v29, v29 row_ror:8 row_mask:0xf bank_mask:0x3
  v_add_f32_dpp v30, v30, v30 row_ror:8 row_mask:0xf bank_mask:0x3
  v_add_f32_dpp v31, v31, v31 row_ror:8 row_mask:0xf bank_mask:0x3
  v_add_f32_dpp v24, v32, v32 row_ror:8 row_mask:0xf bank_mask:0xc
  v_add_f32_dpp v25, v33, v33 row_ror:8 row_mask:0xf bank_mask:0xc
  v_add_f32_dpp v26, v34, v34 row_ror:8 row_mask:0xf bank_mask:0xc
  v_add_f32_dpp v27, v35, v35 row_ror:8 row_mask:0xf bank_mask:0xc
  v_add_f32_dpp v28, v36, v36 row_ror:8 row_mask:0xf bank_mask:0xc
  v_add_f32_dpp v29, v37, v37 row_ror:8 row_mask:0xf bank_mask:0xc
  v_add_f32_dpp v30, v38, v38 row_ror:8 row_mask:0xf bank_mask:0xc
  v_add_f32_dpp v31, v39, v39 row_ror:8 row_mask:0xf bank_mask:0xc
  v_add_f32_dpp v24, v24, v24 row_shl:4 row_mask:0xf bank_mask:0x5
  v_add_f32_dpp v25, v25, v25 row_shl:4 row_mask:0xf bank_mask:0x5
  v_add_f32_dpp v26, v26, v26 row_shl:4 row_mask:0xf bank_mask:0x5
  v_add_f32_dpp v27, v27, v27 row_shl:4 row_mask:0xf bank_mask:0x5
  v_add_f32_dpp v24, v28, v28 row_shr:4 row_mask:0xf bank_mask:0xa
  v_add_f32_dpp v25, v29, v29 row_shr:4 row_mask:0xf bank_mask:0xa
  v_add_f32_dpp v26, v30, v30 row_shr:4 row_mask:0xf bank_mask:0xa
  v_add_f32_dpp v27, v31, v31 row_shr:4 row_mask:0xf bank_mask:0xa
  s_nop 0
  v_add_f32_dpp v42, v24, v24 quad_perm:[2,3,0,1] row_mask:0xf bank_mask:0xf
  v_add_f32_dpp v43, v25, v25 quad_perm:[2,3,0,1] row_mask:0xf bank_mask:0xf
  v_add_f32_dpp v44, v26, v26 quad_perm:[2,3,0,1] row_mask:0xf bank_mask:0xf
  v_add_f32_dpp v45, v27, v27 quad_perm:[2,3,0,1] row_mask:0xf bank_mask:0xf
  v_cndmask_b32_e64 v24, v42, v44, s[88:89]
  v_cndmask_b32_e64 v25, v43, v45, s[88:89]
  s_nop 1
  v_add_f32_dpp v42, v24, v24 quad_perm:[1,0,3,2] row_mask:0xf bank_mask:0xf
  v_add_f32_dpp v43, v25, v25 quad_perm:[1,0,3,2] row_mask:0xf bank_mask:0xf
  v_cndmask_b32_e64 v42, v42, v43, s[86:87]
  v_cvt_pk_bf16_f32 v42, v42, v42
  v_and_b32 v42, 0xffff0000, v42
  v_mul_f32 v42, 0x3db504f3, v42
  v_cvt_pk_bf16_f32 v42, v42, v42
  v_and_b32 v42, 0xffff0000, v42
  v_mov_b32 v43, v42
  s_nop 1
  v_max_f32_dpp v43, v43, v43 row_ror:8 row_mask:0xf bank_mask:0xf
  s_nop 1
  v_max_f32_dpp v43, v43, v43 row_ror:4 row_mask:0xf bank_mask:0xf
  s_nop 1
  v_max_f32_dpp v43, v43, v43 row_ror:2 row_mask:0xf bank_mask:0xf
  s_nop 1
  v_max_f32_dpp v43, v43, v43 row_ror:1 row_mask:0xf bank_mask:0xf
  v_mov_b32 v44, v43
  s_nop 1
  v_permlane16_swap_b32 v43, v44
  s_nop 0
  v_max_f32 v43, v43, v44
  v_mov_b32 v44, v43
  s_nop 1
  v_permlane32_swap_b32 v43, v44
  s_nop 0
  v_max_f32 v43, v43, v44
  v_max_f32 v43, v43, v40
  v_sub_f32 v45, v40, v43
  v_sub_f32 v46, v42, v43
  v_mul_f32 v45, 0x3fb8aa3b, v45
  v_mul_f32 v46, 0x3fb8aa3b, v46
  v_exp_f32 v45, v45
  v_exp_f32 v46, v46
  v_mov_b32 v40, v43
  v_cvt_pk_bf16_f32 v47, v46, v46
  v_fma_f32 v41, v41, v45, v46
  v_mul_f32 v12, v12, v45
  v_mul_f32 v13, v13, v45
  v_mul_f32 v14, v14, v45
  v_mul_f32 v15, v15, v45
  v_and_b32_dpp v16, v47, v8 row_newbcast:0 row_mask:0xf bank_mask:0xf
  v_and_b32_dpp v17, v47, v9 row_newbcast:0 row_mask:0xf bank_mask:0xf
  v_and_b32_dpp v18, v47, v10 row_newbcast:0 row_mask:0xf bank_mask:0xf
  v_and_b32_dpp v19, v47, v11 row_newbcast:0 row_mask:0xf bank_mask:0xf
  v_and_b32_dpp v20, v47, v8 row_newbcast:1 row_mask:0xf bank_mask:0xf
  v_and_b32_dpp v21, v47, v9 row_newbcast:1 row_mask:0xf bank_mask:0xf
  v_and_b32_dpp v22, v47, v10 row_newbcast:1 row_mask:0xf bank_mask:0xf
  v_and_b32_dpp v23, v47, v11 row_newbcast:1 row_mask:0xf bank_mask:0xf
  v_mfma_f32_16x16x32_bf16 v[12:15], v[16:19], a[0:3], v[12:15]
  s_add_u32 s81, s81, 0x10000
  s_and_b32 s81, s81, 0x1fffff
  s_waitcnt vmcnt(5)
  buffer_load_dwordx4 a[0:3], v1, s[48:51], s81 offen nt
  v_and_b32_dpp v16, v47, v8 row_newbcast:2 row_mask:0xf bank_mask:0xf
  v_and_b32_dpp v17, v47, v9 row_newbcast:2 row_mask:0xf bank_mask:0xf
  v_and_b32_dpp v18, v47, v10 row_newbcast:2 row_mask:0xf bank_mask:0xf
  v_and_b32_dpp v19, v47, v11 row_newbcast:2 row_mask:0xf bank_mask:0xf
  v_mfma_f32_16x16x32_bf16 v[12:15], v[20:23], a[4:7], v[12:15]
  s_waitcnt vmcnt(5)
  buffer_load_dwordx4 a[4:7], v1, s[48:51], s81 offen offset:1024 nt
  v_and_b32_dpp v20, v47, v8 row_newbcast:3 row_mask:0xf bank_mask:0xf
  v_and_b32_dpp v21, v47, v9 row_newbcast:3 row_mask:0xf bank_mask:0xf
  v_and_b32_dpp v22, v47, v10 row_newbcast:3 row_mask:0xf bank_mask:0xf
  v_and_b32_dpp v23, v47, v11 row_newbcast:3 row_mask:0xf bank_mask:0xf
  v_mfma_f32_16x16x32_bf16 v[12:15], v[16:19], a[8:11], v[12:15]
  s_waitcnt vmcnt(5)
  buffer_load_dwordx4 a[8:11], v1, s[48:51], s81 offen offset:2048 nt
  v_and_b32_dpp v16, v47, v8 row_newbcast:4 row_mask:0xf bank_mask:0xf
  v_and_b32_dpp v17, v47, v9 row_newbcast:4 row_mask:0xf bank_mask:0xf
  v_and_b32_dpp v18, v47, v10 row_newbcast:4 row_mask:0xf bank_mask:0xf
  v_and_b32_dpp v19, v47, v11 row_newbcast:4 row_mask:0xf bank_mask:0xf
  v_mfma_f32_16x16x32_bf16 v[12:15], v[20:23], a[12:15], v[12:15]
  s_waitcnt vmcnt(5)
  buffer_load_dwordx4 a[12:15], v1, s[48:51], s81 offen offset:3072 nt
  v_and_b32_dpp v20, v47, v8 row_newbcast:5 row_mask:0xf bank_mask:0xf
  v_and_b32_dpp v21, v47, v9 row_newbcast:5 row_mask:0xf bank_mask:0xf
  v_and_b32_dpp v22, v47, v10 row_newbcast:5 row_mask:0xf bank_mask:0xf
  v_and_b32_dpp v23, v47, v11 row_newbcast:5 row_mask:0xf bank_mask:0xf
  v_mfma_f32_16x16x32_bf16 v[12:15], v[16:19], a[16:19], v[12:15]
  s_add_u32 s81, s81, 0x10000
  s_and_b32 s81, s81, 0x1fffff
  s_waitcnt vmcnt(5)
  buffer_load_dwordx4 a[16:19], v1, s[48:51], s81 offen nt
  v_and_b32_dpp v16, v47, v8 row_newbcast:6 row_mask:0xf bank_mask:0xf
  v_and_b32_dpp v17, v47, v9 row_newbcast:6 row_mask:0xf bank_mask:0xf
  v_and_b32_dpp v18, v47, v10 row_newbcast:6 row_mask:0xf bank_mask:0xf
  v_and_b32_dpp v19, v47, v11 row_newbcast:6 row_mask:0xf bank_mask:0xf
  v_mfma_f32_16x16x32_bf16 v[12:15], v[20:23], a[20:23], v[12:15]
  s_waitcnt vmcnt(5)
  buffer_load_dwordx4 a[20:23], v1, s[48:51], s81 offen offset:1024 nt
  v_and_b32_dpp v20, v47, v8 row_newbcast:7 row_mask:0xf bank_mask:0xf
  v_and_b32_dpp v21, v47, v9 row_newbcast:7 row_mask:0xf bank_mask:0xf
  v_and_b32_dpp v22, v47, v10 row_newbcast:7 row_mask:0xf bank_mask:0xf
  v_and_b32_dpp v23, v47, v11 row_newbcast:7 row_mask:0xf bank_mask:0xf
  v_mfma_f32_16x16x32_bf16 v[12:15], v[16:19], a[24:27], v[12:15]
  s_waitcnt vmcnt(5)
  buffer_load_dwordx4 a[24:27], v1, s[48:51], s81 offen offset:2048 nt
  v_and_b32_dpp v16, v47, v8 row_newbcast:8 row_mask:0xf bank_mask:0xf
  v_and_b32_dpp v17, v47, v9 row_newbcast:8 row_mask:0xf bank_mask:0xf
  v_and_b32_dpp v18, v47, v10 row_newbcast:8 row_mask:0xf bank_mask:0xf
  v_and_b32_dpp v19, v47, v11 row_newbcast:8 row_mask:0xf bank_mask:0xf
  v_mfma_f32_16x16x32_bf16 v[12:15], v[20:23], a[28:31], v[12:15]
  s_waitcnt vmcnt(5)
  buffer_load_dwordx4 a[28:31], v1, s[48:51], s81 offen offset:3072 nt
  v_and_b32_dpp v20, v47, v8 row_newbcast:9 row_mask:0xf bank_mask:0xf
  v_and_b32_dpp v21, v47, v9 row_newbcast:9 row_mask:0xf bank_mask:0xf
  v_and_b32_dpp v22, v47, v10 row_newbcast:9 row_mask:0xf bank_mask:0xf
  v_and_b32_dpp v23, v47, v11 row_newbcast:9 row_mask:0xf bank_mask:0xf
  v_mfma_f32_16x16x32_bf16 v[12:15], v[16:19], a[32:35], v[12:15]
  s_add_u32 s81, s81, 0x10000
  s_and_b32 s81, s81, 0x1fffff
  s_waitcnt vmcnt(5)
  buffer_load_dwordx4 a[32:35], v1, s[48:51], s81 offen nt
  buffer_load_dwordx4 a[120:123], v3, s[56:59], s82 offen
  s_add_u32 s82, s82, 4096
  v_and_b32_dpp v16, v47, v8 row_newbcast:10 row_mask:0xf bank_mask:0xf
  v_and_b32_dpp v17, v47, v9 row_newbcast:10 row_mask:0xf bank_mask:0xf
  v_and_b32_dpp v18, v47, v10 row_newbcast:10 row_mask:0xf bank_mask:0xf
  v_and_b32_dpp v19, v47, v11 row_newbcast:10 row_mask:0xf bank_mask:0xf
  v_mfma_f32_16x16x32_bf16 v[12:15], v[20:23], a[36:39], v[12:15]
  s_waitcnt vmcnt(5)
  buffer_load_dwordx4 a[36:39], v1, s[48:51], s81 offen offset:1024 nt
  v_and_b32_dpp v20, v47, v8 row_newbcast:11 row_mask:0xf bank_mask:0xf
  v_and_b32_dpp v21, v47, v9 row_newbcast:11 row_mask:0xf bank_mask:0xf
  v_and_b32_dpp v22, v47, v10 row_newbcast:11 row_mask:0xf bank_mask:0xf
  v_and_b32_dpp v23, v47, v11 row_newbcast:11 row_mask:0xf bank_mask:0xf
  v_mfma_f32_16x16x32_bf16 v[12:15], v[16:19], a[40:43], v[12:15]
  s_waitcnt vmcnt(5)
  buffer_load_dwordx4 a[40:43], v1, s[48:51], s81 offen offset:2048 nt
  v_and_b32_dpp v16, v47, v8 row_newbcast:12 row_mask:0xf bank_mask:0xf
  v_and_b32_dpp v17, v47, v9 row_newbcast:12 row_mask:0xf bank_mask:0xf
  v_and_b32_dpp v18, v47, v10 row_newbcast:12 row_mask:0xf bank_mask:0xf
  v_and_b32_dpp v19, v47, v11 row_newbcast:12 row_mask:0xf bank_mask:0xf
  v_mfma_f32_16x16x32_bf16 v[12:15], v[20:23], a[44:47], v[12:15]
  s_waitcnt vmcnt(5)
  buffer_load_dwordx4 a[44:47], v1, s[48:51], s81 offen offset:3072 nt
  v_and_b32_dpp v20, v47, v8 row_newbcast:13 row_mask:0xf bank_mask:0xf
  v_and_b32_dpp v21, v47, v9 row_newbcast:13 row_mask:0xf bank_mask:0xf
  v_and_b32_dpp v22, v47, v10 row_newbcast:13 row_mask:0xf bank_mask:0xf
  v_and_b32_dpp v23, v47, v11 row_newbcast:13 row_mask:0xf bank_mask:0xf
  v_mfma_f32_16x16x32_bf16 v[12:15], v[16:19], a[48:51], v[12:15]
  s_add_u32 s81, s81, 0x10000
  s_and_b32 s81, s81, 0x1fffff
  s_waitcnt vmcnt(5)
  buffer_load_dwordx4 a[48:51], v1, s[48:51], s81 offen nt
  v_and_b32_dpp v16, v47, v8 row_newbcast:14 row_mask:0xf bank_mask:0xf
  v_and_b32_dpp v17, v47, v9 row_newbcast:14 row_mask:0xf bank_mask:0xf
  v_and_b32_dpp v18, v47, v10 row_newbcast:14 row_mask:0xf bank_mask:0xf
  v_and_b32_dpp v19, v47, v11 row_newbcast:14 row_mask:0xf bank_mask:0xf
  v_mfma_f32_16x16x32_bf16 v[12:15], v[20:23], a[52:55], v[12:15]
  s_waitcnt vmcnt(5)
  buffer_load_dwordx4 a[52:55], v1, s[48:51], s81 offen offset:1024 nt
  v_and_b32_dpp v20, v47, v8 row_newbcast:15 row_mask:0xf bank_mask:0xf
  v_and_b32_dpp v21, v47, v9 row_newbcast:15 row_mask:0xf bank_mask:0xf
  v_and_b32_dpp v22, v47, v10 row_newbcast:15 row_mask:0xf bank_mask:0xf
  v_and_b32_dpp v23, v47, v11 row_newbcast:15 row_mask:0xf bank_mask:0xf
  v_mfma_f32_16x16x32_bf16 v[12:15], v[16:19], a[56:59], v[12:15]
  s_waitcnt vmcnt(5)
  buffer_load_dwordx4 a[56:59], v1, s[48:51], s81 offen offset:2048 nt
  s_nop 1
  v_mfma_f32_16x16x32_bf16 v[12:15], v[20:23], a[60:63], v[12:15]
  s_waitcnt vmcnt(5)
  buffer_load_dwordx4 a[60:63], v1, s[48:51], s81 offen offset:3072 nt
  v_dot2_f32_bf16 v24, v64, v4, 0
  v_dot2_f32_bf16 v24, v65, v5, v24
  v_dot2_f32_bf16 v24, v66, v6, v24
  v_dot2_f32_bf16 v24, v67, v7, v24
  s_add_u32 s80, s80, 0x10000
  s_and_b32 s80, s80, 0x1fffff
  s_waitcnt vmcnt(5)
  buffer_load_dwordx4 v[64:67], v1, s[44:47], s80 offen nt
  v_dot2_f32_bf16 v25, v68, v4, 0
  v_dot2_f32_bf16 v25, v69, v5, v25
  v_dot2_f32_bf16 v25, v70, v6, v25
  v_dot2_f32_bf16 v25, v71, v7, v25
  s_waitcnt vmcnt(5)
  buffer_load_dwordx4 v[68:71], v1, s[44:47], s80 offen offset:1024 nt
  v_dot2_f32_bf16 v26, v72, v4, 0
  v_dot2_f32_bf16 v26, v73, v5, v26
  v_dot2_f32_bf16 v26, v74, v6, v26
  v_dot2_f32_bf16 v26, v75, v7, v26
  s_waitcnt vmcnt(5)
  buffer_load_dwordx4 v[72:75], v1, s[44:47], s80 offen offset:2048 nt
  buffer_load_dwordx4 a[124:127], v3, s[56:59], s82 offen
  s_add_u32 s82, s82, 4096
  v_dot2_f32_bf16 v27, v76, v4, 0
  v_dot2_f32_bf16 v27, v77, v5, v27
  v_dot2_f32_bf16 v27, v78, v6, v27
  v_dot2_f32_bf16 v27, v79, v7, v27
  s_waitcnt vmcnt(5)
  buffer_load_dwordx4 v[76:79], v1, s[44:47], s80 offen offset:3072 nt
  v_dot2_f32_bf16 v28, v80, v4, 0
  v_dot2_f32_bf16 v28, v81, v5, v28
  v_dot2_f32_bf16 v28, v82, v6, v28
  v_dot2_f32_bf16 v28, v83, v7, v28
  s_add_u32 s80, s80, 0x10000
  s_and_b32 s80, s80, 0x1fffff
  s_waitcnt vmcnt(5)
  buffer_load_dwordx4 v[80:83], v1, s[44:47], s80 offen nt
  v_dot2_f32_bf16 v29, v84, v4, 0
  v_dot2_f32_bf16 v29, v85, v5, v29
  v_dot2_f32_bf16 v29, v86, v6, v29
  v_dot2_f32_bf16 v29, v87, v7, v29
  s_waitcnt vmcnt(5)
  buffer_load_dwordx4 v[84:87], v1, s[44:47], s80 offen offset:1024 nt
  v_dot2_f32_bf16 v30, v88, v4, 0
  v_dot2_f32_bf16 v30, v89, v5, v30
  v_dot2_f32_bf16 v30, v90, v6, v30
  v_dot2_f32_bf16 v30, v91, v7, v30
  s_waitcnt vmcnt(5)
  buffer_load_dwordx4 v[88:91], v1, s[44:47], s80 offen offset:2048 nt
  buffer_load_dwordx4 a[128:131], v3, s[56:59], s82 offen
  s_add_u32 s82, s82, 4096
  v_dot2_f32_bf16 v31, v92, v4, 0
  v_dot2_f32_bf16 v31, v93, v5, v31
  v_dot2_f32_bf16 v31, v94, v6, v31
  v_dot2_f32_bf16 v31, v95, v7, v31
  s_waitcnt vmcnt(5)
  buffer_load_dwordx4 v[92:95], v1, s[44:47], s80 offen offset:3072 nt
  v_dot2_f32_bf16 v32, v96, v4, 0
  v_dot2_f32_bf16 v32, v97, v5, v32
  v_dot2_f32_bf16 v32, v98, v6, v32
  v_dot2_f32_bf16 v32, v99, v7, v32
  s_add_u32 s80, s80, 0x10000
  s_and_b32 s80, s80, 0x1fffff
  s_waitcnt vmcnt(5)
  buffer_load_dwordx4 v[96:99], v1, s[44:47], s80 offen nt
  v_dot2_f32_bf16 v33, v100, v4, 0
  v_dot2_f32_bf16 v33, v101, v5, v33
  v_dot2_f32_bf16 v33, v102, v6, v33
  v_dot2_f32_bf16 v33, v103, v7, v33
  s_waitcnt vmcnt(5)
  buffer_load_dwordx4 v[100:103], v1, s[44:47], s80 offen offset:1024 nt
  v_dot2_f32_bf16 v34, v104, v4, 0
  v_dot2_f32_bf16 v34, v105, v5, v34
  v_dot2_f32_bf16 v34, v106, v6, v34
  v_dot2_f32_bf16 v34, v107, v7, v34
  s_waitcnt vmcnt(5)
  buffer_load_dwordx4 v[104:107], v1, s[44:47], s80 offen offset:2048 nt
  buffer_load_dwordx4 a[132:135], v3, s[56:59], s82 offen
  s_add_u32 s82, s82, 4096
  v_dot2_f32_bf16 v35, v108, v4, 0
  v_dot2_f32_bf16 v35, v109, v5, v35
  v_dot2_f32_bf16 v35, v110, v6, v35
  v_dot2_f32_bf16 v35, v111, v7, v35
  s_waitcnt vmcnt(5)
  buffer_load_dwordx4 v[108:111], v1, s[44:47], s80 offen offset:3072 nt
  v_dot2_f32_bf16 v36, v112, v4, 0
  v_dot2_f32_bf16 v36, v113, v5, v36
  v_dot2_f32_bf16 v36, v114, v6, v36
  v_dot2_f32_bf16 v36, v115, v7, v36
  s_add_u32 s80, s80, 0x10000
  s_and_b32 s80, s80, 0x1fffff
  s_waitcnt vmcnt(5)
  buffer_load_dwordx4 v[112:115], v1, s[44:47], s80 offen nt
  v_dot2_f32_bf16 v37, v116, v4, 0
  v_dot2_f32_bf16 v37, v117, v5, v37
  v_dot2_f32_bf16 v37, v118, v6, v37
  v_dot2_f32_bf16 v37, v119, v7, v37
  s_waitcnt vmcnt(5)
  buffer_load_dwordx4 v[116:119], v1, s[44:47], s80 offen offset:1024 nt
  v_dot2_f32_bf16 v38, v120, v4, 0
  v_dot2_f32_bf16 v38, v121, v5, v38
  v_dot2_f32_bf16 v38, v122, v6, v38
  v_dot2_f32_bf16 v38, v123, v7, v38
  s_waitcnt vmcnt(5)
  buffer_load_dwordx4 v[120:123], v1, s[44:47], s80 offen offset:2048 nt
  buffer_load_dwordx4 a[136:139], v3, s[56:59], s82 offen
  s_add_u32 s82, s82, 4096
  v_dot2_f32_bf16 v39, v124, v4, 0
  v_dot2_f32_bf16 v39, v125, v5, v39
  v_dot2_f32_bf16 v39, v126, v6, v39
  v_dot2_f32_bf16 v39, v127, v7, v39
  s_waitcnt vmcnt(5)
  buffer_load_dwordx4 v[124:127], v1, s[44:47], s80 offen offset:3072 nt
  s_nop 2
  v_add_f32_dpp v24, v24, v24 row_ror:8 row_mask:0xf bank_mask:0x3
  v_add_f32_dpp v25, v25, v25 row_ror:8 row_mask:0xf bank_mask:0x3
  v_add_f32_dpp v26, v26, v26 row_ror:8 row_mask:0xf bank_mask:0x3
  v_add_f32_dpp v27, v27, v27 row_ror:8 row_mask:0xf bank_mask:0x3
  v_add_f32_dpp v28, v28, v28 row_ror:8 row_mask:0xf bank_mask:0x3
  v_add_f32_dpp v29, v29, v29 row_ror:8 row_mask:0xf bank_mask:0x3
  v_add_f32_dpp v30, v30, v30 row_ror:8 row_mask:0xf bank_mask:0x3
  v_add_f32_dpp v31, v31, v31 row_ror:8 row_mask:0xf bank_mask:0x3
  v_add_f32_dpp v24, v32, v32 row_ror:8 row_mask:0xf bank_mask:0xc
  v_add_f32_dpp v25, v33, v33 row_ror:8 row_mask:0xf bank_mask:0xc
  v_add_f32_dpp v26, v34, v34 row_ror:8 row_mask:0xf bank_mask:0xc
  v_add_f32_dpp v27, v35, v35 row_ror:8 row_mask:0xf bank_mask:0xc
  v_add_f32_dpp v28, v36, v36 row_ror:8 row_mask:0xf bank_mask:0xc
  v_add_f32_dpp v29, v37, v37 row_ror:8 row_mask:0xf bank_mask:0xc
  s_branch L_over_2
L_stub_2:
  s_branch L_back_0
L_over_2:
  v_add_f32_dpp v30, v38, v38 row_ror:8 row_mask:0xf bank_mask:0xc
  v_add_f32_dpp v31, v39, v39 row_ror:8 row_mask:0xf bank_mask:0xc
  v_add_f32_dpp v24, v24, v24 row_shl:4 row_mask:0xf bank_mask:0x5
  v_add_f32_dpp v25, v25, v25 row_shl:4 row_mask:0xf bank_mask:0x5
  v_add_f32_dpp v26, v26, v26 row_shl:4 row_mask:0xf bank_mask:0x5
  v_add_f32_dpp v27, v27, v27 row_shl:4 row_mask:0xf bank_mask:0x5
  v_add_f32_dpp v24, v28, v28 row_shr:4 row_mask:0xf bank_mask:0xa
  v_add_f32_dpp v25, v29, v29 row_shr:4 row_mask:0xf bank_mask:0xa
  v_add_f32_dpp v26, v30, v30 row_shr:4 row_mask:0xf bank_mask:0xa
  v_add_f32_dpp v27, v31, v31 row_shr:4 row_mask:0xf bank_mask:0xa
  s_nop 0
  v_add_f32_dpp v42, v24, v24 quad_perm:[2,3,0,1] row_mask:0xf bank_mask:0xf
  v_add_f32_dpp v43, v25, v25 quad_perm:[2,3,0,1] row_mask:0xf bank_mask:0xf
  v_add_f32_dpp v44, v26, v26 quad_perm:[2,3,0,1] row_mask:0xf bank_mask:0xf
  v_add_f32_dpp v45, v27, v27 quad_perm:[2,3,0,1] row_mask:0xf bank_mask:0xf
  v_cndmask_b32_e64 v24, v42, v44, s[88:89]
  v_cndmask_b32_e64 v25, v43, v45, s[88:89]
  s_nop 1
  v_add_f32_dpp v42, v24, v24 quad_perm:[1,0,3,2] row_mask:0xf bank_mask:0xf
  v_add_f32_dpp v43, v25, v25 quad_perm:[1,0,3,2] row_mask:0xf bank_mask:0xf
  v_cndmask_b32_e64 v42, v42, v43, s[86:87]
  v_cvt_pk_bf16_f32 v42, v42, v42
  v_and_b32 v42, 0xffff0000, v42
  v_mul_f32 v42, 0x3db504f3, v42
  v_cvt_pk_bf16_f32 v42, v42, v42
  v_and_b32 v42, 0xffff0000, v42
  v_mov_b32 v43, v42
  s_nop 1
  v_max_f32_dpp v43, v43, v43 row_ror:8 row_mask:0xf bank_mask:0xf
  s_nop 1
  v_max_f32_dpp v43, v43, v43 row_ror:4 row_mask:0xf bank_mask:0xf
  s_nop 1
  v_max_f32_dpp v43, v43, v43 row_ror:2 row_mask:0xf bank_mask:0xf
  s_nop 1
  v_max_f32_dpp v43, v43, v43 row_ror:1 row_mask:0xf bank_mask:0xf
  v_mov_b32 v44, v43
  s_nop 1
  v_permlane16_swap_b32 v43, v44
  s_nop 0
  v_max_f32 v43, v43, v44
  v_mov_b32 v44, v43
  s_nop 1
  v_permlane32_swap_b32 v43, v44
  s_nop 0
  v_max_f32 v43, v43, v44
  v_max_f32 v43, v43, v40
  v_sub_f32 v45, v40, v43
  v_sub_f32 v46, v42, v43
  v_mul_f32 v45, 0x3fb8aa3b, v45
  v_mul_f32 v46, 0x3fb8aa3b, v46
  v_exp_f32 v45, v45
  v_exp_f32 v46, v46
  v_mov_b32 v40, v43
  v_cvt_pk_bf16_f32 v47, v46, v46
  v_fma_f32 v41, v41, v45, v46
  v_mul_f32 v12, v12, v45
  v_mul_f32 v13, v13, v45
  v_mul_f32 v14, v14, v45
  v_mul_f32 v15, v15, v45
  v_and_b32_dpp v16, v47, v8 row_newbcast:0 row_mask:0xf bank_mask:0xf
  v_and_b32_dpp v17, v47, v9 row_newbcast:0 row_mask:0xf bank_mask:0xf
  v_and_b32_dpp v18, v47, v10 row_newbcast:0 row_mask:0xf bank_mask:0xf
  v_and_b32_dpp v19, v47, v11 row_newbcast:0 row_mask:0xf bank_mask:0xf
  v_and_b32_dpp v20, v47, v8 row_newbcast:1 row_mask:0xf bank_mask:0xf
  v_and_b32_dpp v21, v47, v9 row_newbcast:1 row_mask:0xf bank_mask:0xf
  v_and_b32_dpp v22, v47, v10 row_newbcast:1 row_mask:0xf bank_mask:0xf
  v_and_b32_dpp v23, v47, v11 row_newbcast:1 row_mask:0xf bank_mask:0xf
  v_mfma_f32_16x16x32_bf16 v[12:15], v[16:19], a[0:3], v[12:15]
  s_add_u32 s81, s81, 0x10000
  s_and_b32 s81, s81, 0x1fffff
  s_waitcnt vmcnt(5)
  buffer_load_dwordx4 a[0:3], v1, s[48:51], s81 offen nt
  v_and_b32_dpp v16, v47, v8 row_newbcast:2 row_mask:0xf bank_mask:0xf
  v_and_b32_dpp v17, v47, v9 row_newbcast:2 row_mask:0xf bank_mask:0xf
  v_and_b32_dpp v18, v47, v10 row_newbcast:2 row_mask:0xf bank_mask:0xf
  v_and_b32_dpp v19, v47, v11 row_newbcast:2 row_mask:0xf bank_mask:0xf
  v_mfma_f32_16x16x32_bf16 v[12:15], v[20:23], a[4:7], v[12:15]
  s_waitcnt vmcnt(5)
  buffer_load_dwordx4 a[4:7], v1, s[48:51], s81 offen offset:1024 nt
  v_and_b32_dpp v20, v47, v8 row_newbcast:3 row_mask:0xf bank_mask:0xf
  v_and_b32_dpp v21, v47, v9 row_newbcast:3 row_mask:0xf bank_mask:0xf
  v_and_b32_dpp v22, v47, v10 row_newbcast:3 row_mask:0xf bank_mask:0xf
  v_and_b32_dpp v23, v47, v11 row_newbcast:3 row_mask:0xf bank_mask:0xf
  v_mfma_f32_16x16x32_bf16 v[12:15], v[16:19], a[8:11], v[12:15]
  s_waitcnt vmcnt(5)
  buffer_load_dwordx4 a[8:11], v1, s[48:51], s81 offen offset:2048 nt
  v_and_b32_dpp v16, v47, v8 row_newbcast:4 row_mask:0xf bank_mask:0xf
  v_and_b32_dpp v17, v47, v9 row_newbcast:4 row_mask:0xf bank_mask:0xf
  v_and_b32_dpp v18, v47, v10 row_newbcast:4 row_mask:0xf bank_mask:0xf
  v_and_b32_dpp v19, v47, v11 row_newbcast:4 row_mask:0xf bank_mask:0xf
  v_mfma_f32_16x16x32_bf16 v[12:15], v[20:23], a[12:15], v[12:15]
  s_waitcnt vmcnt(5)
  buffer_load_dwordx4 a[12:15], v1, s[48:51], s81 offen offset:3072 nt
  v_and_b32_dpp v20, v47, v8 row_newbcast:5 row_mask:0xf bank_mask:0xf
  v_and_b32_dpp v21, v47, v9 row_newbcast:5 row_mask:0xf bank_mask:0xf
  v_and_b32_dpp v22, v47, v10 row_newbcast:5 row_mask:0xf bank_mask:0xf
  v_and_b32_dpp v23, v47, v11 row_newbcast:5 row_mask:0xf bank_mask:0xf
  v_mfma_f32_16x16x32_bf16 v[12:15], v[16:19], a[16:19], v[12:15]
  s_add_u32 s81, s81, 0x10000
  s_and_b32 s81, s81, 0x1fffff
  s_waitcnt vmcnt(5)
  buffer_load_dwordx4 a[16:19], v1, s[48:51], s81 offen nt
  v_and_b32_dpp v16, v47, v8 row_newbcast:6 row_mask:0xf bank_mask:0xf
  v_and_b32_dpp v17, v47, v9 row_newbcast:6 row_mask:0xf bank_mask:0xf
  v_and_b32_dpp v18, v47, v10 row_newbcast:6 row_mask:0xf bank_mask:0xf
  v_and_b32_dpp v19, v47, v11 row_newbcast:6 row_mask:0xf bank_mask:0xf
  v_mfma_f32_16x16x32_bf16 v[12:15], v[20:23], a[20:23], v[12:15]
  s_waitcnt vmcnt(5)
  buffer_load_dwordx4 a[20:23], v1, s[48:51], s81 offen offset:1024 nt
  v_and_b32_dpp v20, v47, v8 row_newbcast:7 row_mask:0xf bank_mask:0xf
  v_and_b32_dpp v21, v47, v9 row_newbcast:7 row_mask:0xf bank_mask:0xf
  v_and_b32_dpp v22, v47, v10 row_newbcast:7 row_mask:0xf bank_mask:0xf
  v_and_b32_dpp v23, v47, v11 row_newbcast:7 row_mask:0xf bank_mask:0xf
  v_mfma_f32_16x16x32_bf16 v[12:15], v[16:19], a[24:27], v[12:15]
  s_waitcnt vmcnt(5)
  buffer_load_dwordx4 a[24:27], v1, s[48:51], s81 offen offset:2048 nt
  v_and_b32_dpp v16, v47, v8 row_newbcast:8 row_mask:0xf bank_mask:0xf
  v_and_b32_dpp v17, v47, v9 row_newbcast:8 row_mask:0xf bank_mask:0xf
  v_and_b32_dpp v18, v47, v10 row_newbcast:8 row_mask:0xf bank_mask:0xf
  v_and_b32_dpp v19, v47, v11 row_newbcast:8 row_mask:0xf bank_mask:0xf
  v_mfma_f32_16x16x32_bf16 v[12:15], v[20:23], a[28:31], v[12:15]
  s_waitcnt vmcnt(5)
  buffer_load_dwordx4 a[28:31], v1, s[48:51], s81 offen offset:3072 nt
  v_and_b32_dpp v20, v47, v8 row_newbcast:9 row_mask:0xf bank_mask:0xf
  v_and_b32_dpp v21, v47, v9 row_newbcast:9 row_mask:0xf bank_mask:0xf
  v_and_b32_dpp v22, v47, v10 row_newbcast:9 row_mask:0xf bank_mask:0xf
  v_and_b32_dpp v23, v47, v11 row_newbcast:9 row_mask:0xf bank_mask:0xf
  v_mfma_f32_16x16x32_bf16 v[12:15], v[16:19], a[32:35], v[12:15]
  s_add_u32 s81, s81, 0x10000
  s_and_b32 s81, s81, 0x1fffff
  s_waitcnt vmcnt(5)
  buffer_load_dwordx4 a[32:35], v1, s[48:51], s81 offen nt
  buffer_load_dwordx4 a[140:143], v3, s[56:59], s82 offen
  s_add_u32 s82, s82, 4096
  v_and_b32_dpp v16, v47, v8 row_newbcast:10 row_mask:0xf bank_mask:0xf
  v_and_b32_dpp v17, v47, v9 row_newbcast:10 row_mask:0xf bank_mask:0xf
  v_and_b32_dpp v18, v47, v10 row_newbcast:10 row_mask:0xf bank_mask:0xf
  v_and_b32_dpp v19, v47, v11 row_newbcast:10 row_mask:0xf bank_mask:0xf
  v_mfma_f32_16x16x32_bf16 v[12:15], v[20:23], a[36:39], v[12:15]
  s_waitcnt vmcnt(5)
  buffer_load_dwordx4 a[36:39], v1, s[48:51], s81 offen offset:1024 nt
  v_and_b32_dpp v20, v47, v8 row_newbcast:11 row_mask:0xf bank_mask:0xf
  v_and_b32_dpp v21, v47, v9 row_newbcast:11 row_mask:0xf bank_mask:0xf
  v_and_b32_dpp v22, v47, v10 row_newbcast:11 row_mask:0xf bank_mask:0xf
  v_and_b32_dpp v23, v47, v11 row_newbcast:11 row_mask:0xf bank_mask:0xf
  v_mfma_f32_16x16x32_bf16 v[12:15], v[16:19], a[40:43], v[12:15]
  s_waitcnt vmcnt(5)
  buffer_load_dwordx4 a[40:43], v1, s[48:51], s81 offen offset:2048 nt
  v_and_b32_dpp v16, v47, v8 row_newbcast:12 row_mask:0xf bank_mask:0xf
  v_and_b32_dpp v17, v47, v9 row_newbcast:12 row_mask:0xf bank_mask:0xf
  v_and_b32_dpp v18, v47, v10 row_newbcast:12 row_mask:0xf bank_mask:0xf
  v_and_b32_dpp v19, v47, v11 row_newbcast:12 row_mask:0xf bank_mask:0xf
  v_mfma_f32_16x16x32_bf16 v[12:15], v[20:23], a[44:47], v[12:15]
  s_waitcnt vmcnt(5)
  buffer_load_dwordx4 a[44:47], v1, s[48:51], s81 offen offset:3072 nt
  v_and_b32_dpp v20, v47, v8 row_newbcast:13 row_mask:0xf bank_mask:0xf
  v_and_b32_dpp v21, v47, v9 row_newbcast:13 row_mask:0xf bank_mask:0xf
  v_and_b32_dpp v22, v47, v10 row_newbcast:13 row_mask:0xf bank_mask:0xf
  v_and_b32_dpp v23, v47, v11 row_newbcast:13 row_mask:0xf bank_mask:0xf
  v_mfma_f32_16x16x32_bf16 v[12:15], v[16:19], a[48:51], v[12:15]
  s_add_u32 s81, s81, 0x10000
  s_and_b32 s81, s81, 0x1fffff
  s_waitcnt vmcnt(5)
  buffer_load_dwordx4 a[48:51], v1, s[48:51], s81 offen nt
  v_and_b32_dpp v16, v47, v8 row_newbcast:14 row_mask:0xf bank_mask:0xf
  v_and_b32_dpp v17, v47, v9 row_newbcast:14 row_mask:0xf bank_mask:0xf
  v_and_b32_dpp v18, v47, v10 row_newbcast:14 row_mask:0xf bank_mask:0xf
  v_and_b32_dpp v19, v47, v11 row_newbcast:14 row_mask:0xf bank_mask:0xf
  v_mfma_f32_16x16x32_bf16 v[12:15], v[20:23], a[52:55], v[12:15]
  s_waitcnt vmcnt(5)
  buffer_load_dwordx4 a[52:55], v1, s[48:51], s81 offen offset:1024 nt
  v_and_b32_dpp v20, v47, v8 row_newbcast:15 row_mask:0xf bank_mask:0xf
  v_and_b32_dpp v21, v47, v9 row_newbcast:15 row_mask:0xf bank_mask:0xf
  v_and_b32_dpp v22, v47, v10 row_newbcast:15 row_mask:0xf bank_mask:0xf
  v_and_b32_dpp v23, v47, v11 row_newbcast:15 row_mask:0xf bank_mask:0xf
  v_mfma_f32_16x16x32_bf16 v[12:15], v[16:19], a[56:59], v[12:15]
  s_waitcnt vmcnt(5)
  buffer_load_dwordx4 a[56:59], v1, s[48:51], s81 offen offset:2048 nt
  s_nop 1
  v_mfma_f32_16x16x32_bf16 v[12:15], v[20:23], a[60:63], v[12:15]
  s_waitcnt vmcnt(5)
  buffer_load_dwordx4 a[60:63], v1, s[48:51], s81 offen offset:3072 nt
  v_dot2_f32_bf16 v24, v64, v4, 0
  v_dot2_f32_bf16 v24, v65, v5, v24
  v_dot2_f32_bf16 v24, v66, v6, v24
  v_dot2_f32_bf16 v24, v67, v7, v24
  s_add_u32 s80, s80, 0x10000
  s_and_b32 s80, s80, 0x1fffff
  s_waitcnt vmcnt(5)
  buffer_load_dwordx4 v[64:67], v1, s[44:47], s80 offen nt
  v_dot2_f32_bf16 v25, v68, v4, 0
  v_dot2_f32_bf16 v25, v69, v5, v25
  v_dot2_f32_bf16 v25, v70, v6, v25
  v_dot2_f32_bf16 v25, v71, v7, v25
  s_waitcnt vmcnt(5)
  buffer_load_dwordx4 v[68:71], v1, s[44:47], s80 offen offset:1024 nt
  v_dot2_f32_bf16 v26, v72, v4, 0
  v_dot2_f32_bf16 v26, v73, v5, v26
  v_dot2_f32_bf16 v26, v74, v6, v26
  v_dot2_f32_bf16 v26, v75, v7, v26
  s_waitcnt vmcnt(5)
  buffer_load_dwordx4 v[72:75], v1, s[44:47], s80 offen offset:2048 nt
  buffer_load_dwordx4 a[144:147], v3, s[56:59], s82 offen
  s_add_u32 s82, s82, 4096
  v_dot2_f32_bf16 v27, v76, v4, 0
  v_dot2_f32_bf16 v27, v77, v5, v27
  v_dot2_f32_bf16 v27, v78, v6, v27
  v_dot2_f32_bf16 v27, v79, v7, v27
  s_waitcnt vmcnt(5)
  buffer_load_dwordx4 v[76:79], v1, s[44:47], s80 offen offset:3072 nt
  v_dot2_f32_bf16 v28, v80, v4, 0
  v_dot2_f32_bf16 v28, v81, v5, v28
  v_dot2_f32_bf16 v28, v82, v6, v28
  v_dot2_f32_bf16 v28, v83, v7, v28
  s_add_u32 s80, s80, 0x10000
  s_and_b32 s80, s80, 0x1fffff
  s_waitcnt vmcnt(5)
  buffer_load_dwordx4 v[80:83], v1, s[44:47], s80 offen nt
  v_dot2_f32_bf16 v29, v84, v4, 0
  v_dot2_f32_bf16 v29, v85, v5, v29
  v_dot2_f32_bf16 v29, v86, v6, v29
  v_dot2_f32_bf16 v29, v87, v7, v29
  s_waitcnt vmcnt(5)
  buffer_load_dwordx4 v[84:87], v1, s[44:47], s80 offen offset:1024 nt
  v_dot2_f32_bf16 v30, v88, v4, 0
  v_dot2_f32_bf16 v30, v89, v5, v30
  v_dot2_f32_bf16 v30, v90, v6, v30
  v_dot2_f32_bf16 v30, v91, v7, v30
  s_waitcnt vmcnt(5)
  buffer_load_dwordx4 v[88:91], v1, s[44:47], s80 offen offset:2048 nt
  buffer_load_dwordx4 a[148:151], v3, s[56:59], s82 offen
  s_add_u32 s82, s82, 4096
  v_dot2_f32_bf16 v31, v92, v4, 0
  v_dot2_f32_bf16 v31, v93, v5, v31
  v_dot2_f32_bf16 v31, v94, v6, v31
  v_dot2_f32_bf16 v31, v95, v7, v31
  s_waitcnt vmcnt(5)
  buffer_load_dwordx4 v[92:95], v1, s[44:47], s80 offen offset:3072 nt
  v_dot2_f32_bf16 v32, v96, v4, 0
  v_dot2_f32_bf16 v32, v97, v5, v32
  v_dot2_f32_bf16 v32, v98, v6, v32
  v_dot2_f32_bf16 v32, v99, v7, v32
  s_add_u32 s80, s80, 0x10000
  s_and_b32 s80, s80, 0x1fffff
  s_waitcnt vmcnt(5)
  buffer_load_dwordx4 v[96:99], v1, s[44:47], s80 offen nt
  v_dot2_f32_bf16 v33, v100, v4, 0
  v_dot2_f32_bf16 v33, v101, v5, v33
  v_dot2_f32_bf16 v33, v102, v6, v33
  v_dot2_f32_bf16 v33, v103, v7, v33
  s_waitcnt vmcnt(5)
  buffer_load_dwordx4 v[100:103], v1, s[44:47], s80 offen offset:1024 nt
  v_dot2_f32_bf16 v34, v104, v4, 0
  v_dot2_f32_bf16 v34, v105, v5, v34
  v_dot2_f32_bf16 v34, v106, v6, v34
  v_dot2_f32_bf16 v34, v107, v7, v34
  s_waitcnt vmcnt(5)
  buffer_load_dwordx4 v[104:107], v1, s[44:47], s80 offen offset:2048 nt
  buffer_load_dwordx4 a[152:155], v3, s[56:59], s82 offen
  s_add_u32 s82, s82, 4096
  v_dot2_f32_bf16 v35, v108, v4, 0
  v_dot2_f32_bf16 v35, v109, v5, v35
  v_dot2_f32_bf16 v35, v110, v6, v35
  v_dot2_f32_bf16 v35, v111, v7, v35
  s_waitcnt vmcnt(5)
  buffer_load_dwordx4 v[108:111], v1, s[44:47], s80 offen offset:3072 nt
  v_dot2_f32_bf16 v36, v112, v4, 0
  v_dot2_f32_bf16 v36, v113, v5, v36
  v_dot2_f32_bf16 v36, v114, v6, v36
  v_dot2_f32_bf16 v36, v115, v7, v36
  s_add_u32 s80, s80, 0x10000
  s_and_b32 s80, s80, 0x1fffff
  s_waitcnt vmcnt(5)
  buffer_load_dwordx4 v[112:115], v1, s[44:47], s80 offen nt
  v_dot2_f32_bf16 v37, v116, v4, 0
  v_dot2_f32_bf16 v37, v117, v5, v37
  v_dot2_f32_bf16 v37, v118, v6, v37
  v_dot2_f32_bf16 v37, v119, v7, v37
  s_waitcnt vmcnt(5)
  buffer_load_dwordx4 v[116:119], v1, s[44:47], s80 offen offset:1024 nt
  v_dot2_f32_bf16 v38, v120, v4, 0
  v_dot2_f32_bf16 v38, v121, v5, v38
  v_dot2_f32_bf16 v38, v122, v6, v38
  v_dot2_f32_bf16 v38, v123, v7, v38
  s_waitcnt vmcnt(5)
  buffer_load_dwordx4 v[120:123], v1, s[44:47], s80 offen offset:2048 nt
  buffer_load_dwordx4 a[156:159], v3, s[56:59], s82 offen
  s_add_u32 s82, s82, 4096
  v_dot2_f32_bf16 v39, v124, v4, 0
  v_dot2_f32_bf16 v39, v125, v5, v39
  v_dot2_f32_bf16 v39, v126, v6, v39
  v_dot2_f32_bf16 v39, v127, v7, v39
  s_waitcnt vmcnt(5)
  buffer_load_dwordx4 v[124:127], v1, s[44:47], s80 offen offset:3072 nt
  s_nop 2
  v_add_f32_dpp v24, v24, v24 row_ror:8 row_mask:0xf bank_mask:0x3
  v_add_f32_dpp v25, v25, v25 row_ror:8 row_mask:0xf bank_mask:0x3
  v_add_f32_dpp v26, v26, v26 row_ror:8 row_mask:0xf bank_mask:0x3
  v_add_f32_dpp v27, v27, v27 row_ror:8 row_mask:0xf bank_mask:0x3
  v_add_f32_dpp v28, v28, v28 row_ror:8 row_mask:0xf bank_mask:0x3
  v_add_f32_dpp v29, v29, v29 row_ror:8 row_mask:0xf bank_mask:0x3
  v_add_f32_dpp v30, v30, v30 row_ror:8 row_mask:0xf bank_mask:0x3
  v_add_f32_dpp v31, v31, v31 row_ror:8 row_mask:0xf bank_mask:0x3
  v_add_f32_dpp v24, v32, v32 row_ror:8 row_mask:0xf bank_mask:0xc
  v_add_f32_dpp v25, v33, v33 row_ror:8 row_mask:0xf bank_mask:0xc
  v_add_f32_dpp v26, v34, v34 row_ror:8 row_mask:0xf bank_mask:0xc
  v_add_f32_dpp v27, v35, v35 row_ror:8 row_mask:0xf bank_mask:0xc
  v_add_f32_dpp v28, v36, v36 row_ror:8 row_mask:0xf bank_mask:0xc
  v_add_f32_dpp v29, v37, v37 row_ror:8 row_mask:0xf bank_mask:0xc
  v_add_f32_dpp v30, v38, v38 row_ror:8 row_mask:0xf bank_mask:0xc
  v_add_f32_dpp v31, v39, v39 row_ror:8 row_mask:0xf bank_mask:0xc
  v_add_f32_dpp v24, v24, v24 row_shl:4 row_mask:0xf bank_mask:0x5
  v_add_f32_dpp v25, v25, v25 row_shl:4 row_mask:0xf bank_mask:0x5
  v_add_f32_dpp v26, v26, v26 row_shl:4 row_mask:0xf bank_mask:0x5
  v_add_f32_dpp v27, v27, v27 row_shl:4 row_mask:0xf bank_mask:0x5
  v_add_f32_dpp v24, v28, v28 row_shr:4 row_mask:0xf bank_mask:0xa
  v_add_f32_dpp v25, v29, v29 row_shr:4 row_mask:0xf bank_mask:0xa
  v_add_f32_dpp v26, v30, v30 row_shr:4 row_mask:0xf bank_mask:0xa
  v_add_f32_dpp v27, v31, v31 row_shr:4 row_mask:0xf bank_mask:0xa
  s_nop 0
  v_add_f32_dpp v42, v24, v24 quad_perm:[2,3,0,1] row_mask:0xf bank_mask:0xf
  v_add_f32_dpp v43, v25, v25 quad_perm:[2,3,0,1] row_mask:0xf bank_mask:0xf
  v_add_f32_dpp v44, v26, v26 quad_perm:[2,3,0,1] row_mask:0xf bank_mask:0xf
  v_add_f32_dpp v45, v27, v27 quad_perm:[2,3,0,1] row_mask:0xf bank_mask:0xf
  v_cndmask_b32_e64 v24, v42, v44, s[88:89]
  v_cndmask_b32_e64 v25, v43, v45, s[88:89]
  s_nop 1
  v_add_f32_dpp v42, v24, v24 quad_perm:[1,0,3,2] row_mask:0xf bank_mask:0xf
  v_add_f32_dpp v43, v25, v25 quad_perm:[1,0,3,2] row_mask:0xf bank_mask:0xf
  v_cndmask_b32_e64 v42, v42, v43, s[86:87]
  v_cvt_pk_bf16_f32 v42, v42, v42
  v_and_b32 v42, 0xffff0000, v42
  v_mul_f32 v42, 0x3db504f3, v42
  v_cvt_pk_bf16_f32 v42, v42, v42
  v_and_b32 v42, 0xffff0000, v42
  v_mov_b32 v43, v42
  s_nop 1
  v_max_f32_dpp v43, v43, v43 row_ror:8 row_mask:0xf bank_mask:0xf
  s_nop 1
  v_max_f32_dpp v43, v43, v43 row_ror:4 row_mask:0xf bank_mask:0xf
  s_nop 1
  v_max_f32_dpp v43, v43, v43 row_ror:2 row_mask:0xf bank_mask:0xf
  s_nop 1
  v_max_f32_dpp v43, v43, v43 row_ror:1 row_mask:0xf bank_mask:0xf
  v_mov_b32 v44, v43
  s_nop 1
  v_permlane16_swap_b32 v43, v44
  s_nop 0
  v_max_f32 v43, v43, v44
  v_mov_b32 v44, v43
  s_nop 1
  v_permlane32_swap_b32 v43, v44
  s_nop 0
  v_max_f32 v43, v43, v44
  v_max_f32 v43, v43, v40
  v_sub_f32 v45, v40, v43
  v_sub_f32 v46, v42, v43
  v_mul_f32 v45, 0x3fb8aa3b, v45
  v_mul_f32 v46, 0x3fb8aa3b, v46
  v_exp_f32 v45, v45
  v_exp_f32 v46, v46
  v_mov_b32 v40, v43
  v_cvt_pk_bf16_f32 v47, v46, v46
  v_fma_f32 v41, v41, v45, v46
  v_mul_f32 v12, v12, v45
  v_mul_f32 v13, v13, v45
  v_mul_f32 v14, v14, v45
  v_mul_f32 v15, v15, v45
  v_and_b32_dpp v16, v47, v8 row_newbcast:0 row_mask:0xf bank_mask:0xf
  v_and_b32_dpp v17, v47, v9 row_newbcast:0 row_mask:0xf bank_mask:0xf
  v_and_b32_dpp v18, v47, v10 row_newbcast:0 row_mask:0xf bank_mask:0xf
  v_and_b32_dpp v19, v47, v11 row_newbcast:0 row_mask:0xf bank_mask:0xf
  v_and_b32_dpp v20, v47, v8 row_newbcast:1 row_mask:0xf bank_mask:0xf
  v_and_b32_dpp v21, v47, v9 row_newbcast:1 row_mask:0xf bank_mask:0xf
  v_and_b32_dpp v22, v47, v10 row_newbcast:1 row_mask:0xf bank_mask:0xf
  v_and_b32_dpp v23, v47, v11 row_newbcast:1 row_mask:0xf bank_mask:0xf
  v_mfma_f32_16x16x32_bf16 v[12:15], v[16:19], a[0:3], v[12:15]
  s_add_u32 s81, s81, 0x10000
  s_and_b32 s81, s81, 0x1fffff
  s_waitcnt vmcnt(5)
  buffer_load_dwordx4 a[0:3], v1, s[48:51], s81 offen nt
  v_and_b32_dpp v16, v47, v8 row_newbcast:2 row_mask:0xf bank_mask:0xf
  v_and_b32_dpp v17, v47, v9 row_newbcast:2 row_mask:0xf bank_mask:0xf
  v_and_b32_dpp v18, v47, v10 row_newbcast:2 row_mask:0xf bank_mask:0xf
  v_and_b32_dpp v19, v47, v11 row_newbcast:2 row_mask:0xf bank_mask:0xf
  v_mfma_f32_16x16x32_bf16 v[12:15], v[20:23], a[4:7], v[12:15]
  s_waitcnt vmcnt(5)
  buffer_load_dwordx4 a[4:7], v1, s[48:51], s81 offen offset:1024 nt
  v_and_b32_dpp v20, v47, v8 row_newbcast:3 row_mask:0xf bank_mask:0xf
  v_and_b32_dpp v21, v47, v9 row_newbcast:3 row_mask:0xf bank_mask:0xf
  v_and_b32_dpp v22, v47, v10 row_newbcast:3 row_mask:0xf bank_mask:0xf
  v_and_b32_dpp v23, v47, v11 row_newbcast:3 row_mask:0xf bank_mask:0xf
  v_mfma_f32_16x16x32_bf16 v[12:15], v[16:19], a[8:11], v[12:15]
  s_waitcnt vmcnt(5)
  buffer_load_dwordx4 a[8:11], v1, s[48:51], s81 offen offset:2048 nt
  v_and_b32_dpp v16, v47, v8 row_newbcast:4 row_mask:0xf bank_mask:0xf
  v_and_b32_dpp v17, v47, v9 row_newbcast:4 row_mask:0xf bank_mask:0xf
  v_and_b32_dpp v18, v47, v10 row_newbcast:4 row_mask:0xf bank_mask:0xf
  v_and_b32_dpp v19, v47, v11 row_newbcast:4 row_mask:0xf bank_mask:0xf
  v_mfma_f32_16x16x32_bf16 v[12:15], v[20:23], a[12:15], v[12:15]
  s_waitcnt vmcnt(5)
  buffer_load_dwordx4 a[12:15], v1, s[48:51], s81 offen offset:3072 nt
  v_and_b32_dpp v20, v47, v8 row_newbcast:5 row_mask:0xf bank_mask:0xf
  v_and_b32_dpp v21, v47, v9 row_newbcast:5 row_mask:0xf bank_mask:0xf
  v_and_b32_dpp v22, v47, v10 row_newbcast:5 row_mask:0xf bank_mask:0xf
  v_and_b32_dpp v23, v47, v11 row_newbcast:5 row_mask:0xf bank_mask:0xf
  v_mfma_f32_16x16x32_bf16 v[12:15], v[16:19], a[16:19], v[12:15]
  s_add_u32 s81, s81, 0x10000
  s_and_b32 s81, s81, 0x1fffff
  s_waitcnt vmcnt(5)
  buffer_load_dwordx4 a[16:19], v1, s[48:51], s81 offen nt
  v_and_b32_dpp v16, v47, v8 row_newbcast:6 row_mask:0xf bank_mask:0xf
  v_and_b32_dpp v17, v47, v9 row_newbcast:6 row_mask:0xf bank_mask:0xf
  v_and_b32_dpp v18, v47, v10 row_newbcast:6 row_mask:0xf bank_mask:0xf
  v_and_b32_dpp v19, v47, v11 row_newbcast:6 row_mask:0xf bank_mask:0xf
  v_mfma_f32_16x16x32_bf16 v[12:15], v[20:23], a[20:23], v[12:15]
  s_waitcnt vmcnt(5)
  buffer_load_dwordx4 a[20:23], v1, s[48:51], s81 offen offset:1024 nt
  v_and_b32_dpp v20, v47, v8 row_newbcast:7 row_mask:0xf bank_mask:0xf
  v_and_b32_dpp v21, v47, v9 row_newbcast:7 row_mask:0xf bank_mask:0xf
  v_and_b32_dpp v22, v47, v10 row_newbcast:7 row_mask:0xf bank_mask:0xf
  v_and_b32_dpp v23, v47, v11 row_newbcast:7 row_mask:0xf bank_mask:0xf
  v_mfma_f32_16x16x32_bf16 v[12:15], v[16:19], a[24:27], v[12:15]
  s_waitcnt vmcnt(5)
  buffer_load_dwordx4 a[24:27], v1, s[48:51], s81 offen offset:2048 nt
  v_and_b32_dpp v16, v47, v8 row_newbcast:8 row_mask:0xf bank_mask:0xf
  v_and_b32_dpp v17, v47, v9 row_newbcast:8 row_mask:0xf bank_mask:0xf
  v_and_b32_dpp v18, v47, v10 row_newbcast:8 row_mask:0xf bank_mask:0xf
  v_and_b32_dpp v19, v47, v11 row_newbcast:8 row_mask:0xf bank_mask:0xf
  v_mfma_f32_16x16x32_bf16 v[12:15], v[20:23], a[28:31], v[12:15]
  s_waitcnt vmcnt(5)
  buffer_load_dwordx4 a[28:31], v1, s[48:51], s81 offen offset:3072 nt
  v_and_b32_dpp v20, v47, v8 row_newbcast:9 row_mask:0xf bank_mask:0xf
  v_and_b32_dpp v21, v47, v9 row_newbcast:9 row_mask:0xf bank_mask:0xf
  v_and_b32_dpp v22, v47, v10 row_newbcast:9 row_mask:0xf bank_mask:0xf
  v_and_b32_dpp v23, v47, v11 row_newbcast:9 row_mask:0xf bank_mask:0xf
  v_mfma_f32_16x16x32_bf16 v[12:15], v[16:19], a[32:35], v[12:15]
  s_add_u32 s81, s81, 0x10000
  s_and_b32 s81, s81, 0x1fffff
  s_waitcnt vmcnt(5)
  buffer_load_dwordx4 a[32:35], v1, s[48:51], s81 offen nt
  v_and_b32_dpp v16, v47, v8 row_newbcast:10 row_mask:0xf bank_mask:0xf
  v_and_b32_dpp v17, v47, v9 row_newbcast:10 row_mask:0xf bank_mask:0xf
  v_and_b32_dpp v18, v47, v10 row_newbcast:10 row_mask:0xf bank_mask:0xf
  v_and_b32_dpp v19, v47, v11 row_newbcast:10 row_mask:0xf bank_mask:0xf
  v_mfma_f32_16x16x32_bf16 v[12:15], v[20:23], a[36:39], v[12:15]
  s_waitcnt vmcnt(5)
  buffer_load_dwordx4 a[36:39], v1, s[48:51], s81 offen offset:1024 nt
  v_and_b32_dpp v20, v47, v8 row_newbcast:11 row_mask:0xf bank_mask:0xf
  v_and_b32_dpp v21, v47, v9 row_newbcast:11 row_mask:0xf bank_mask:0xf
  v_and_b32_dpp v22, v47, v10 row_newbcast:11 row_mask:0xf bank_mask:0xf
  v_and_b32_dpp v23, v47, v11 row_newbcast:11 row_mask:0xf bank_mask:0xf
  v_mfma_f32_16x16x32_bf16 v[12:15], v[16:19], a[40:43], v[12:15]
  s_waitcnt vmcnt(5)
  buffer_load_dwordx4 a[40:43], v1, s[48:51], s81 offen offset:2048 nt
  v_and_b32_dpp v16, v47, v8 row_newbcast:12 row_mask:0xf bank_mask:0xf
  v_and_b32_dpp v17, v47, v9 row_newbcast:12 row_mask:0xf bank_mask:0xf
  v_and_b32_dpp v18, v47, v10 row_newbcast:12 row_mask:0xf bank_mask:0xf
  v_and_b32_dpp v19, v47, v11 row_newbcast:12 row_mask:0xf bank_mask:0xf
  v_mfma_f32_16x16x32_bf16 v[12:15], v[20:23], a[44:47], v[12:15]
  s_waitcnt vmcnt(5)
  buffer_load_dwordx4 a[44:47], v1, s[48:51], s81 offen offset:3072 nt
  v_and_b32_dpp v20, v47, v8 row_newbcast:13 row_mask:0xf bank_mask:0xf
  v_and_b32_dpp v21, v47, v9 row_newbcast:13 row_mask:0xf bank_mask:0xf
  v_and_b32_dpp v22, v47, v10 row_newbcast:13 row_mask:0xf bank_mask:0xf
  v_and_b32_dpp v23, v47, v11 row_newbcast:13 row_mask:0xf bank_mask:0xf
  v_mfma_f32_16x16x32_bf16 v[12:15], v[16:19], a[48:51], v[12:15]
  s_add_u32 s81, s81, 0x10000
  s_and_b32 s81, s81, 0x1fffff
  s_waitcnt vmcnt(5)
  buffer_load_dwordx4 a[48:51], v1, s[48:51], s81 offen nt
  v_and_b32_dpp v16, v47, v8 row_newbcast:14 row_mask:0xf bank_mask:0xf
  v_and_b32_dpp v17, v47, v9 row_newbcast:14 row_mask:0xf bank_mask:0xf
  v_and_b32_dpp v18, v47, v10 row_newbcast:14 row_mask:0xf bank_mask:0xf
  v_and_b32_dpp v19, v47, v11 row_newbcast:14 row_mask:0xf bank_mask:0xf
  v_mfma_f32_16x16x32_bf16 v[12:15], v[20:23], a[52:55], v[12:15]
  s_waitcnt vmcnt(5)
  buffer_load_dwordx4 a[52:55], v1, s[48:51], s81 offen offset:1024 nt
  v_and_b32_dpp v20, v47, v8 row_newbcast:15 row_mask:0xf bank_mask:0xf
  v_and_b32_dpp v21, v47, v9 row_newbcast:15 row_mask:0xf bank_mask:0xf
  v_and_b32_dpp v22, v47, v10 row_newbcast:15 row_mask:0xf bank_mask:0xf
  v_and_b32_dpp v23, v47, v11 row_newbcast:15 row_mask:0xf bank_mask:0xf
  v_mfma_f32_16x16x32_bf16 v[12:15], v[16:19], a[56:59], v[12:15]
  s_waitcnt vmcnt(5)
  buffer_load_dwordx4 a[56:59], v1, s[48:51], s81 offen offset:2048 nt
  s_nop 1
  v_mfma_f32_16x16x32_bf16 v[12:15], v[20:23], a[60:63], v[12:15]
  s_waitcnt vmcnt(5)
  buffer_load_dwordx4 a[60:63], v1, s[48:51], s81 offen offset:3072 nt
  v_dot2_f32_bf16 v24, v64, v4, 0
  v_dot2_f32_bf16 v24, v65, v5, v24
  v_dot2_f32_bf16 v24, v66, v6, v24
  v_dot2_f32_bf16 v24, v67, v7, v24
  s_add_u32 s80, s80, 0x10000
  s_and_b32 s80, s80, 0x1fffff
  buffer_load_dwordx4 v[64:67], v1, s[44:47], s80 offen nt
  v_dot2_f32_bf16 v25, v68, v4, 0
  v_dot2_f32_bf16 v25, v69, v5, v25
  v_dot2_f32_bf16 v25, v70, v6, v25
  v_dot2_f32_bf16 v25, v71, v7, v25
  buffer_load_dwordx4 v[68:71], v1, s[44:47], s80 offen offset:1024 nt
  v_dot2_f32_bf16 v26, v72, v4, 0
  v_dot2_f32_bf16 v26, v73, v5, v26
  v_dot2_f32_bf16 v26, v74, v6, v26
  v_dot2_f32_bf16 v26, v75, v7, v26
  buffer_load_dwordx4 v[72:75], v1, s[44:47], s80 offen offset:2048 nt
  buffer_load_dwordx4 a[160:163], v3, s[56:59], s82 offen
  s_add_u32 s82, s82, 4096
  v_dot2_f32_bf16 v27, v76, v4, 0
  v_dot2_f32_bf16 v27, v77, v5, v27
  v_dot2_f32_bf16 v27, v78, v6, v27
  v_dot2_f32_bf16 v27, v79, v7, v27
  buffer_load_dwordx4 v[76:79], v1, s[44:47], s80 offen offset:3072 nt
  v_dot2_f32_bf16 v28, v80, v4, 0
  v_dot2_f32_bf16 v28, v81, v5, v28
  v_dot2_f32_bf16 v28, v82, v6, v28
  v_dot2_f32_bf16 v28, v83, v7, v28
  s_add_u32 s80, s80, 0x10000
  s_and_b32 s80, s80, 0x1fffff
  buffer_load_dwordx4 v[80:83], v1, s[44:47], s80 offen nt
  v_dot2_f32_bf16 v29, v84, v4, 0
  v_dot2_f32_bf16 v29, v85, v5, v29
  v_dot2_f32_bf16 v29, v86, v6, v29
  v_dot2_f32_bf16 v29, v87, v7, v29
  buffer_load_dwordx4 v[84:87], v1, s[44:47], s80 offen offset:1024 nt
  v_dot2_f32_bf16 v30, v88, v4, 0
  v_dot2_f32_bf16 v30, v89, v5, v30
  v_dot2_f32_bf16 v30, v90, v6, v30
  v_dot2_f32_bf16 v30, v91, v7, v30
  buffer_load_dwordx4 v[88:91], v1, s[44:47], s80 offen offset:2048 nt
  buffer_load_dwordx4 a[164:167], v3, s[56:59], s82 offen
  s_add_u32 s82, s82, 4096
  v_dot2_f32_bf16 v31, v92, v4, 0
  v_dot2_f32_bf16 v31, v93, v5, v31
  v_dot2_f32_bf16 v31, v94, v6, v31
  v_dot2_f32_bf16 v31, v95, v7, v31
  buffer_load_dwordx4 v[92:95], v1, s[44:47], s80 offen offset:3072 nt
  v_dot2_f32_bf16 v32, v96, v4, 0
  v_dot2_f32_bf16 v32, v97, v5, v32
  v_dot2_f32_bf16 v32, v98, v6, v32
  v_dot2_f32_bf16 v32, v99, v7, v32
  s_add_u32 s80, s80, 0x10000
  s_and_b32 s80, s80, 0x1fffff
  s_waitcnt vmcnt(15)
  buffer_load_dwordx4 v[96:99], v1, s[44:47], s80 offen nt
  v_dot2_f32_bf16 v33, v100, v4, 0
  v_dot2_f32_bf16 v33, v101, v5, v33
  v_dot2_f32_bf16 v33, v102, v6, v33
  v_dot2_f32_bf16 v33, v103, v7, v33
  s_waitcnt vmcnt(15)
  buffer_load_dwordx4 v[100:103], v1, s[44:47], s80 offen offset:1024 nt
  v_dot2_f32_bf16 v34, v104, v4, 0
  v_dot2_f32_bf16 v34, v105, v5, v34
  v_dot2_f32_bf16 v34, v106, v6, v34
  v_dot2_f32_bf16 v34, v107, v7, v34
  s_waitcnt vmcnt(15)
  buffer_load_dwordx4 v[104:107], v1, s[44:47], s80 offen offset:2048 nt
  buffer_load_dwordx4 a[168:171], v3, s[56:59], s82 offen
  s_add_u32 s82, s82, 4096
  v_dot2_f32_bf16 v35, v108, v4, 0
  v_dot2_f32_bf16 v35, v109, v5, v35
  v_dot2_f32_bf16 v35, v110, v6, v35
  v_dot2_f32_bf16 v35, v111, v7, v35
  s_waitcnt vmcnt(15)
  buffer_load_dwordx4 v[108:111], v1, s[44:47], s80 offen offset:3072 nt
  s_branch L_over_3
L_stub_3:
  s_branch L_back_0
L_over_3:
  v_dot2_f32_bf16 v36, v112, v4, 0
  v_dot2_f32_bf16 v36, v113, v5, v36
  v_dot2_f32_bf16 v36, v114, v6, v36
  v_dot2_f32_bf16 v36, v115, v7, v36
  s_add_u32 s80, s80, 0x10000
  s_and_b32 s80, s80, 0x1fffff
  s_waitcnt vmcnt(15)
  buffer_load_dwordx4 v[112:115], v1, s[44:47], s80 offen nt
  v_dot2_f32_bf16 v37, v116, v4, 0
  v_dot2_f32_bf16 v37, v117, v5, v37
  v_dot2_f32_bf16 v37, v118, v6, v37
  v_dot2_f32_bf16 v37, v119, v7, v37
  s_waitcnt vmcnt(15)
  buffer_load_dwordx4 v[116:119], v1, s[44:47], s80 offen offset:1024 nt
  v_dot2_f32_bf16 v38, v120, v4, 0
  v_dot2_f32_bf16 v38, v121, v5, v38
  v_dot2_f32_bf16 v38, v122, v6, v38
  v_dot2_f32_bf16 v38, v123, v7, v38
  s_waitcnt vmcnt(15)
  buffer_load_dwordx4 v[120:123], v1, s[44:47], s80 offen offset:2048 nt
  buffer_load_dwordx4 a[172:175], v3, s[56:59], s82 offen
  s_add_u32 s82, s82, 4096
  v_dot2_f32_bf16 v39, v124, v4, 0
  v_dot2_f32_bf16 v39, v125, v5, v39
  v_dot2_f32_bf16 v39, v126, v6, v39
  v_dot2_f32_bf16 v39, v127, v7, v39
  s_waitcnt vmcnt(15)
  buffer_load_dwordx4 v[124:127], v1, s[44:47], s80 offen offset:3072 nt
  s_nop 2
  v_add_f32_dpp v24, v24, v24 row_ror:8 row_mask:0xf bank_mask:0x3
  v_add_f32_dpp v25, v25, v25 row_ror:8 row_mask:0xf bank_mask:0x3
  v_add_f32_dpp v26, v26, v26 row_ror:8 row_mask:0xf bank_mask:0x3
  v_add_f32_dpp v27, v27, v27 row_ror:8 row_mask:0xf bank_mask:0x3
  v_add_f32_dpp v28, v28, v28 row_ror:8 row_mask:0xf bank_mask:0x3
  v_add_f32_dpp v29, v29, v29 row_ror:8 row_mask:0xf bank_mask:0x3
  v_add_f32_dpp v30, v30, v30 row_ror:8 row_mask:0xf bank_mask:0x3
  v_add_f32_dpp v31, v31, v31 row_ror:8 row_mask:0xf bank_mask:0x3
  v_add_f32_dpp v24, v32, v32 row_ror:8 row_mask:0xf bank_mask:0xc
  v_add_f32_dpp v25, v33, v33 row_ror:8 row_mask:0xf bank_mask:0xc
  v_add_f32_dpp v26, v34, v34 row_ror:8 row_mask:0xf bank_mask:0xc
  v_add_f32_dpp v27, v35, v35 row_ror:8 row_mask:0xf bank_mask:0xc
  v_add_f32_dpp v28, v36, v36 row_ror:8 row_mask:0xf bank_mask:0xc
  v_add_f32_dpp v29, v37, v37 row_ror:8 row_mask:0xf bank_mask:0xc
  v_add_f32_dpp v30, v38, v38 row_ror:8 row_mask:0xf bank_mask:0xc
  v_add_f32_dpp v31, v39, v39 row_ror:8 row_mask:0xf bank_mask:0xc
  v_add_f32_dpp v24, v24, v24 row_shl:4 row_mask:0xf bank_mask:0x5
  v_add_f32_dpp v25, v25, v25 row_shl:4 row_mask:0xf bank_mask:0x5
  v_add_f32_dpp v26, v26, v26 row_shl:4 row_mask:0xf bank_mask:0x5
  v_add_f32_dpp v27, v27, v27 row_shl:4 row_mask:0xf bank_mask:0x5
  v_add_f32_dpp v24, v28, v28 row_shr:4 row_mask:0xf bank_mask:0xa
  v_add_f32_dpp v25, v29, v29 row_shr:4 row_mask:0xf bank_mask:0xa
  v_add_f32_dpp v26, v30, v30 row_shr:4 row_mask:0xf bank_mask:0xa
  v_add_f32_dpp v27, v31, v31 row_shr:4 row_mask:0xf bank_mask:0xa
  s_nop 0
  v_add_f32_dpp v42, v24, v24 quad_perm:[2,3,0,1] row_mask:0xf bank_mask:0xf
  v_add_f32_dpp v43, v25, v25 quad_perm:[2,3,0,1] row_mask:0xf bank_mask:0xf
  v_add_f32_dpp v44, v26, v26 quad_perm:[2,3,0,1] row_mask:0xf bank_mask:0xf
  v_add_f32_dpp v45, v27, v27 quad_perm:[2,3,0,1] row_mask:0xf bank_mask:0xf
  v_cndmask_b32_e64 v24, v42, v44, s[88:89]
  v_cndmask_b32_e64 v25, v43, v45, s[88:89]
  s_nop 1
  v_add_f32_dpp v42, v24, v24 quad_perm:[1,0,3,2] row_mask:0xf bank_mask:0xf
  v_add_f32_dpp v43, v25, v25 quad_perm:[1,0,3,2] row_mask:0xf bank_mask:0xf
  v_cndmask_b32_e64 v42, v42, v43, s[86:87]
  v_cvt_pk_bf16_f32 v42, v42, v42
  v_and_b32 v42, 0xffff0000, v42
  v_mul_f32 v42, 0x3db504f3, v42
  v_cvt_pk_bf16_f32 v42, v42, v42
  v_and_b32 v42, 0xffff0000, v42
  v_mov_b32 v43, v42
  s_nop 1
  v_max_f32_dpp v43, v43, v43 row_ror:8 row_mask:0xf bank_mask:0xf
  s_nop 1
  v_max_f32_dpp v43, v43, v43 row_ror:4 row_mask:0xf bank_mask:0xf
  s_nop 1
  v_max_f32_dpp v43, v43, v43 row_ror:2 row_mask:0xf bank_mask:0xf
  s_nop 1
  v_max_f32_dpp v43, v43, v43 row_ror:1 row_mask:0xf bank_mask:0xf
  v_mov_b32 v44, v43
  s_nop 1
  v_permlane16_swap_b32 v43, v44
  s_nop 0
  v_max_f32 v43, v43, v44
  v_mov_b32 v44, v43
  s_nop 1
  v_permlane32_swap_b32 v43, v44
  s_nop 0
  v_max_f32 v43, v43, v44
  v_max_f32 v43, v43, v40
  v_sub_f32 v45, v40, v43
  v_sub_f32 v46, v42, v43
  v_mul_f32 v45, 0x3fb8aa3b, v45
  v_mul_f32 v46, 0x3fb8aa3b, v46
  v_exp_f32 v45, v45
  v_exp_f32 v46, v46
  v_mov_b32 v40, v43
  v_cvt_pk_bf16_f32 v47, v46, v46
  v_fma_f32 v41, v41, v45, v46
  v_mul_f32 v12, v12, v45
  v_mul_f32 v13, v13, v45
  v_mul_f32 v14, v14, v45
  v_mul_f32 v15, v15, v45
  v_and_b32_dpp v16, v47, v8 row_newbcast:0 row_mask:0xf bank_mask:0xf
  v_and_b32_dpp v17, v47, v9 row_newbcast:0 row_mask:0xf bank_mask:0xf
  v_and_b32_dpp v18, v47, v10 row_newbcast:0 row_mask:0xf bank_mask:0xf
  v_and_b32_dpp v19, v47, v11 row_newbcast:0 row_mask:0xf bank_mask:0xf
  v_and_b32_dpp v20, v47, v8 row_newbcast:1 row_mask:0xf bank_mask:0xf
  v_and_b32_dpp v21, v47, v9 row_newbcast:1 row_mask:0xf bank_mask:0xf
  v_and_b32_dpp v22, v47, v10 row_newbcast:1 row_mask:0xf bank_mask:0xf
  v_and_b32_dpp v23, v47, v11 row_newbcast:1 row_mask:0xf bank_mask:0xf
  v_mfma_f32_16x16x32_bf16 v[12:15], v[16:19], a[0:3], v[12:15]
  s_add_u32 s81, s81, 0x10000
  s_and_b32 s81, s81, 0x1fffff
  s_waitcnt vmcnt(15)
  buffer_load_dwordx4 a[0:3], v1, s[48:51], s81 offen nt
  v_and_b32_dpp v16, v47, v8 row_newbcast:2 row_mask:0xf bank_mask:0xf
  v_and_b32_dpp v17, v47, v9 row_newbcast:2 row_mask:0xf bank_mask:0xf
  v_and_b32_dpp v18, v47, v10 row_newbcast:2 row_mask:0xf bank_mask:0xf
  v_and_b32_dpp v19, v47, v11 row_newbcast:2 row_mask:0xf bank_mask:0xf
  v_mfma_f32_16x16x32_bf16 v[12:15], v[20:23], a[4:7], v[12:15]
  s_waitcnt vmcnt(15)
  buffer_load_dwordx4 a[4:7], v1, s[48:51], s81 offen offset:1024 nt
  v_and_b32_dpp v20, v47, v8 row_newbcast:3 row_mask:0xf bank_mask:0xf
  v_and_b32_dpp v21, v47, v9 row_newbcast:3 row_mask:0xf bank_mask:0xf
  v_and_b32_dpp v22, v47, v10 row_newbcast:3 row_mask:0xf bank_mask:0xf
  v_and_b32_dpp v23, v47, v11 row_newbcast:3 row_mask:0xf bank_mask:0xf
  v_mfma_f32_16x16x32_bf16 v[12:15], v[16:19], a[8:11], v[12:15]
  s_waitcnt vmcnt(15)
  buffer_load_dwordx4 a[8:11], v1, s[48:51], s81 offen offset:2048 nt
  v_and_b32_dpp v16, v47, v8 row_newbcast:4 row_mask:0xf bank_mask:0xf
  v_and_b32_dpp v17, v47, v9 row_newbcast:4 row_mask:0xf bank_mask:0xf
  v_and_b32_dpp v18, v47, v10 row_newbcast:4 row_mask:0xf bank_mask:0xf
  v_and_b32_dpp v19, v47, v11 row_newbcast:4 row_mask:0xf bank_mask:0xf
  v_mfma_f32_16x16x32_bf16 v[12:15], v[20:23], a[12:15], v[12:15]
  s_waitcnt vmcnt(15)
  buffer_load_dwordx4 a[12:15], v1, s[48:51], s81 offen offset:3072 nt
  v_and_b32_dpp v20, v47, v8 row_newbcast:5 row_mask:0xf bank_mask:0xf
  v_and_b32_dpp v21, v47, v9 row_newbcast:5 row_mask:0xf bank_mask:0xf
  v_and_b32_dpp v22, v47, v10 row_newbcast:5 row_mask:0xf bank_mask:0xf
  v_and_b32_dpp v23, v47, v11 row_newbcast:5 row_mask:0xf bank_mask:0xf
  v_mfma_f32_16x16x32_bf16 v[12:15], v[16:19], a[16:19], v[12:15]
  s_add_u32 s81, s81, 0x10000
  s_and_b32 s81, s81, 0x1fffff
  s_waitcnt vmcnt(15)
  buffer_load_dwordx4 a[16:19], v1, s[48:51], s81 offen nt
  v_and_b32_dpp v16, v47, v8 row_newbcast:6 row_mask:0xf bank_mask:0xf
  v_and_b32_dpp v17, v47, v9 row_newbcast:6 row_mask:0xf bank_mask:0xf
  v_and_b32_dpp v18, v47, v10 row_newbcast:6 row_mask:0xf bank_mask:0xf
  v_and_b32_dpp v19, v47, v11 row_newbcast:6 row_mask:0xf bank_mask:0xf
  v_mfma_f32_16x16x32_bf16 v[12:15], v[20:23], a[20:23], v[12:15]
  s_waitcnt vmcnt(15)
  buffer_load_dwordx4 a[20:23], v1, s[48:51], s81 offen offset:1024 nt
  v_and_b32_dpp v20, v47, v8 row_newbcast:7 row_mask:0xf bank_mask:0xf
  v_and_b32_dpp v21, v47, v9 row_newbcast:7 row_mask:0xf bank_mask:0xf
  v_and_b32_dpp v22, v47, v10 row_newbcast:7 row_mask:0xf bank_mask:0xf
  v_and_b32_dpp v23, v47, v11 row_newbcast:7 row_mask:0xf bank_mask:0xf
  v_mfma_f32_16x16x32_bf16 v[12:15], v[16:19], a[24:27], v[12:15]
  s_waitcnt vmcnt(15)
  buffer_load_dwordx4 a[24:27], v1, s[48:51], s81 offen offset:2048 nt
  v_and_b32_dpp v16, v47, v8 row_newbcast:8 row_mask:0xf bank_mask:0xf
  v_and_b32_dpp v17, v47, v9 row_newbcast:8 row_mask:0xf bank_mask:0xf
  v_and_b32_dpp v18, v47, v10 row_newbcast:8 row_mask:0xf bank_mask:0xf
  v_and_b32_dpp v19, v47, v11 row_newbcast:8 row_mask:0xf bank_mask:0xf
  v_mfma_f32_16x16x32_bf16 v[12:15], v[20:23], a[28:31], v[12:15]
  s_waitcnt vmcnt(15)
  buffer_load_dwordx4 a[28:31], v1, s[48:51], s81 offen offset:3072 nt
  v_and_b32_dpp v20, v47, v8 row_newbcast:9 row_mask:0xf bank_mask:0xf
  v_and_b32_dpp v21, v47, v9 row_newbcast:9 row_mask:0xf bank_mask:0xf
  v_and_b32_dpp v22, v47, v10 row_newbcast:9 row_mask:0xf bank_mask:0xf
  v_and_b32_dpp v23, v47, v11 row_newbcast:9 row_mask:0xf bank_mask:0xf
  v_mfma_f32_16x16x32_bf16 v[12:15], v[16:19], a[32:35], v[12:15]
  s_add_u32 s81, s81, 0x10000
  s_and_b32 s81, s81, 0x1fffff
  s_waitcnt vmcnt(15)
  buffer_load_dwordx4 a[32:35], v1, s[48:51], s81 offen nt
  v_and_b32_dpp v16, v47, v8 row_newbcast:10 row_mask:0xf bank_mask:0xf
  v_and_b32_dpp v17, v47, v9 row_newbcast:10 row_mask:0xf bank_mask:0xf
  v_and_b32_dpp v18, v47, v10 row_newbcast:10 row_mask:0xf bank_mask:0xf
  v_and_b32_dpp v19, v47, v11 row_newbcast:10 row_mask:0xf bank_mask:0xf
  v_mfma_f32_16x16x32_bf16 v[12:15], v[20:23], a[36:39], v[12:15]
  s_waitcnt vmcnt(15)
  buffer_load_dwordx4 a[36:39], v1, s[48:51], s81 offen offset:1024 nt
  v_and_b32_dpp v20, v47, v8 row_newbcast:11 row_mask:0xf bank_mask:0xf
  v_and_b32_dpp v21, v47, v9 row_newbcast:11 row_mask:0xf bank_mask:0xf
  v_and_b32_dpp v22, v47, v10 row_newbcast:11 row_mask:0xf bank_mask:0xf
  v_and_b32_dpp v23, v47, v11 row_newbcast:11 row_mask:0xf bank_mask:0xf
  v_mfma_f32_16x16x32_bf16 v[12:15], v[16:19], a[40:43], v[12:15]
  s_waitcnt vmcnt(15)
  buffer_load_dwordx4 a[40:43], v1, s[48:51], s81 offen offset:2048 nt
  v_and_b32_dpp v16, v47, v8 row_newbcast:12 row_mask:0xf bank_mask:0xf
  v_and_b32_dpp v17, v47, v9 row_newbcast:12 row_mask:0xf bank_mask:0xf
  v_and_b32_dpp v18, v47, v10 row_newbcast:12 row_mask:0xf bank_mask:0xf
  v_and_b32_dpp v19, v47, v11 row_newbcast:12 row_mask:0xf bank_mask:0xf
  v_mfma_f32_16x16x32_bf16 v[12:15], v[20:23], a[44:47], v[12:15]
  s_waitcnt vmcnt(15)
  buffer_load_dwordx4 a[44:47], v1, s[48:51], s81 offen offset:3072 nt
  v_and_b32_dpp v20, v47, v8 row_newbcast:13 row_mask:0xf bank_mask:0xf
  v_and_b32_dpp v21, v47, v9 row_newbcast:13 row_mask:0xf bank_mask:0xf
  v_and_b32_dpp v22, v47, v10 row_newbcast:13 row_mask:0xf bank_mask:0xf
  v_and_b32_dpp v23, v47, v11 row_newbcast:13 row_mask:0xf bank_mask:0xf
  v_mfma_f32_16x16x32_bf16 v[12:15], v[16:19], a[48:51], v[12:15]
  s_add_u32 s81, s81, 0x10000
  s_and_b32 s81, s81, 0x1fffff
  s_waitcnt vmcnt(15)
  buffer_load_dwordx4 a[48:51], v1, s[48:51], s81 offen nt
  v_and_b32_dpp v16, v47, v8 row_newbcast:14 row_mask:0xf bank_mask:0xf
  v_and_b32_dpp v17, v47, v9 row_newbcast:14 row_mask:0xf bank_mask:0xf
  v_and_b32_dpp v18, v47, v10 row_newbcast:14 row_mask:0xf bank_mask:0xf
  v_and_b32_dpp v19, v47, v11 row_newbcast:14 row_mask:0xf bank_mask:0xf
  v_mfma_f32_16x16x32_bf16 v[12:15], v[20:23], a[52:55], v[12:15]
  s_waitcnt vmcnt(15)
  buffer_load_dwordx4 a[52:55], v1, s[48:51], s81 offen offset:1024 nt
  v_and_b32_dpp v20, v47, v8 row_newbcast:15 row_mask:0xf bank_mask:0xf
  v_and_b32_dpp v21, v47, v9 row_newbcast:15 row_mask:0xf bank_mask:0xf
  v_and_b32_dpp v22, v47, v10 row_newbcast:15 row_mask:0xf bank_mask:0xf
  v_and_b32_dpp v23, v47, v11 row_newbcast:15 row_mask:0xf bank_mask:0xf
  v_mfma_f32_16x16x32_bf16 v[12:15], v[16:19], a[56:59], v[12:15]
  s_waitcnt vmcnt(15)
  buffer_load_dwordx4 a[56:59], v1, s[48:51], s81 offen offset:2048 nt
  s_nop 1
  v_mfma_f32_16x16x32_bf16 v[12:15], v[20:23], a[60:63], v[12:15]
  s_waitcnt vmcnt(15)
  buffer_load_dwordx4 a[60:63], v1, s[48:51], s81 offen offset:3072 nt
  v_dot2_f32_bf16 v24, v64, v4, 0
  v_dot2_f32_bf16 v24, v65, v5, v24
  v_dot2_f32_bf16 v24, v66, v6, v24
  v_dot2_f32_bf16 v24, v67, v7, v24
  s_add_u32 s80, s80, 0x10000
  s_and_b32 s80, s80, 0x1fffff
  s_waitcnt vmcnt(15)
  buffer_load_dwordx4 v[64:67], v1, s[44:47], s80 offen nt
  s_mov_b32 s10, 0xc1000
  buffer_load_dwordx4 v[240:243], v1, s[60:63], s10 offen
  v_dot2_f32_bf16 v25, v68, v4, 0
  v_dot2_f32_bf16 v25, v69, v5, v25
  v_dot2_f32_bf16 v25, v70, v6, v25
  v_dot2_f32_bf16 v25, v71, v7, v25
  s_waitcnt vmcnt(15)
  buffer_load_dwordx4 v[68:71], v1, s[44:47], s80 offen offset:1024 nt
  v_dot2_f32_bf16 v26, v72, v4, 0
  v_dot2_f32_bf16 v26, v73, v5, v26
  v_dot2_f32_bf16 v26, v74, v6, v26
  v_dot2_f32_bf16 v26, v75, v7, v26
  s_waitcnt vmcnt(15)
  buffer_load_dwordx4 v[72:75], v1, s[44:47], s80 offen offset:2048 nt
  buffer_load_dwordx4 a[176:179], v3, s[56:59], s82 offen
  s_add_u32 s82, s82, 4096
  v_dot2_f32_bf16 v27, v76, v4, 0
  v_dot2_f32_bf16 v27, v77, v5, v27
  v_dot2_f32_bf16 v27, v78, v6, v27
  v_dot2_f32_bf16 v27, v79, v7, v27
  s_waitcnt vmcnt(15)
  buffer_load_dwordx4 v[76:79], v1, s[44:47], s80 offen offset:3072 nt
  v_dot2_f32_bf16 v28, v80, v4, 0
  v_dot2_f32_bf16 v28, v81, v5, v28
  v_dot2_f32_bf16 v28, v82, v6, v28
  v_dot2_f32_bf16 v28, v83, v7, v28
  s_add_u32 s80, s80, 0x10000
  s_and_b32 s80, s80, 0x1fffff
  s_waitcnt vmcnt(15)
  buffer_load_dwordx4 v[80:83], v1, s[44:47], s80 offen nt
  v_dot2_f32_bf16 v29, v84, v4, 0
  v_dot2_f32_bf16 v29, v85, v5, v29
  v_dot2_f32_bf16 v29, v86, v6, v29
  v_dot2_f32_bf16 v29, v87, v7, v29
  s_waitcnt vmcnt(15)
  buffer_load_dwordx4 v[84:87], v1, s[44:47], s80 offen offset:1024 nt
  v_dot2_f32_bf16 v30, v88, v4, 0
  v_dot2_f32_bf16 v30, v89, v5, v30
  v_dot2_f32_bf16 v30, v90, v6, v30
  v_dot2_f32_bf16 v30, v91, v7, v30
  s_waitcnt vmcnt(15)
  buffer_load_dwordx4 v[88:91], v1, s[44:47], s80 offen offset:2048 nt
  buffer_load_dwordx4 a[180:183], v3, s[56:59], s82 offen
  s_add_u32 s82, s82, 4096
  v_dot2_f32_bf16 v31, v92, v4, 0
  v_dot2_f32_bf16 v31, v93, v5, v31
  v_dot2_f32_bf16 v31, v94, v6, v31
  v_dot2_f32_bf16 v31, v95, v7, v31
  s_waitcnt vmcnt(15)
  buffer_load_dwordx4 v[92:95], v1, s[44:47], s80 offen offset:3072 nt
  v_dot2_f32_bf16 v32, v96, v4, 0
  v_dot2_f32_bf16 v32, v97, v5, v32
  v_dot2_f32_bf16 v32, v98, v6, v32
  v_dot2_f32_bf16 v32, v99, v7, v32
  s_add_u32 s80, s80, 0x10000
  s_and_b32 s80, s80, 0x1fffff
  s_waitcnt vmcnt(15)
  buffer_load_dwordx4 v[96:99], v1, s[44:47], s80 offen nt
  v_dot2_f32_bf16 v33, v100, v4, 0
  v_dot2_f32_bf16 v33, v101, v5, v33
  v_dot2_f32_bf16 v33, v102, v6, v33
  v_dot2_f32_bf16 v33, v103, v7, v33
  s_waitcnt vmcnt(15)
  buffer_load_dwordx4 v[100:103], v1, s[44:47], s80 offen offset:1024 nt
  v_dot2_f32_bf16 v34, v104, v4, 0
  v_dot2_f32_bf16 v34, v105, v5, v34
  v_dot2_f32_bf16 v34, v106, v6, v34
  v_dot2_f32_bf16 v34, v107, v7, v34
  s_waitcnt vmcnt(15)
  buffer_load_dwordx4 v[104:107], v1, s[44:47], s80 offen offset:2048 nt
  buffer_load_dwordx4 a[184:187], v3, s[56:59], s82 offen
  s_add_u32 s82, s82, 4096
  v_dot2_f32_bf16 v35, v108, v4, 0
  v_dot2_f32_bf16 v35, v109, v5, v35
  v_dot2_f32_bf16 v35, v110, v6, v35
  v_dot2_f32_bf16 v35, v111, v7, v35
  s_waitcnt vmcnt(15)
  buffer_load_dwordx4 v[108:111], v1, s[44:47], s80 offen offset:3072 nt
  v_dot2_f32_bf16 v36, v112, v4, 0
  v_dot2_f32_bf16 v36, v113, v5, v36
  v_dot2_f32_bf16 v36, v114, v6, v36
  v_dot2_f32_bf16 v36, v115, v7, v36
  s_add_u32 s80, s80, 0x10000
  s_and_b32 s80, s80, 0x1fffff
  s_waitcnt vmcnt(15)
  buffer_load_dwordx4 v[112:115], v1, s[44:47], s80 offen nt
  v_dot2_f32_bf16 v37, v116, v4, 0
  v_dot2_f32_bf16 v37, v117, v5, v37
  v_dot2_f32_bf16 v37, v118, v6, v37
  v_dot2_f32_bf16 v37, v119, v7, v37
  s_waitcnt vmcnt(15)
  buffer_load_dwordx4 v[116:119], v1, s[44:47], s80 offen offset:1024 nt
  v_dot2_f32_bf16 v38, v120, v4, 0
  v_dot2_f32_bf16 v38, v121, v5, v38
  v_dot2_f32_bf16 v38, v122, v6, v38
  v_dot2_f32_bf16 v38, v123, v7, v38
  s_waitcnt vmcnt(15)
  buffer_load_dwordx4 v[120:123], v1, s[44:47], s80 offen offset:2048 nt
  buffer_load_dwordx4 a[188:191], v3, s[56:59], s82 offen
  s_add_u32 s82, s82, 4096
  v_dot2_f32_bf16 v39, v124, v4, 0
  v_dot2_f32_bf16 v39, v125, v5, v39
  v_dot2_f32_bf16 v39, v126, v6, v39
  v_dot2_f32_bf16 v39, v127, v7, v39
  s_waitcnt vmcnt(15)
  buffer_load_dwordx4 v[124:127], v1, s[44:47], s80 offen offset:3072 nt
  s_nop 2
  v_add_f32_dpp v24, v24, v24 row_ror:8 row_mask:0xf bank_mask:0x3
  v_add_f32_dpp v25, v25, v25 row_ror:8 row_mask:0xf bank_mask:0x3
  v_add_f32_dpp v26, v26, v26 row_ror:8 row_mask:0xf bank_mask:0x3
  v_add_f32_dpp v27, v27, v27 row_ror:8 row_mask:0xf bank_mask:0x3
  v_add_f32_dpp v28, v28, v28 row_ror:8 row_mask:0xf bank_mask:0x3
  v_add_f32_dpp v29, v29, v29 row_ror:8 row_mask:0xf bank_mask:0x3
  v_add_f32_dpp v30, v30, v30 row_ror:8 row_mask:0xf bank_mask:0x3
  v_add_f32_dpp v31, v31, v31 row_ror:8 row_mask:0xf bank_mask:0x3
  v_add_f32_dpp v24, v32, v32 row_ror:8 row_mask:0xf bank_mask:0xc
  v_add_f32_dpp v25, v33, v33 row_ror:8 row_mask:0xf bank_mask:0xc
  v_add_f32_dpp v26, v34, v34 row_ror:8 row_mask:0xf bank_mask:0xc
  v_add_f32_dpp v27, v35, v35 row_ror:8 row_mask:0xf bank_mask:0xc
  v_add_f32_dpp v28, v36, v36 row_ror:8 row_mask:0xf bank_mask:0xc
  v_add_f32_dpp v29, v37, v37 row_ror:8 row_mask:0xf bank_mask:0xc
  v_add_f32_dpp v30, v38, v38 row_ror:8 row_mask:0xf bank_mask:0xc
  v_add_f32_dpp v31, v39, v39 row_ror:8 row_mask:0xf bank_mask:0xc
  v_add_f32_dpp v24, v24, v24 row_shl:4 row_mask:0xf bank_mask:0x5
  v_add_f32_dpp v25, v25, v25 row_shl:4 row_mask:0xf bank_mask:0x5
  v_add_f32_dpp v26, v26, v26 row_shl:4 row_mask:0xf bank_mask:0x5
  v_add_f32_dpp v27, v27, v27 row_shl:4 row_mask:0xf bank_mask:0x5
  v_add_f32_dpp v24, v28, v28 row_shr:4 row_mask:0xf bank_mask:0xa
  v_add_f32_dpp v25, v29, v29 row_shr:4 row_mask:0xf bank_mask:0xa
  v_add_f32_dpp v26, v30, v30 row_shr:4 row_mask:0xf bank_mask:0xa
  v_add_f32_dpp v27, v31, v31 row_shr:4 row_mask:0xf bank_mask:0xa
  s_nop 0
  v_add_f32_dpp v42, v24, v24 quad_perm:[2,3,0,1] row_mask:0xf bank_mask:0xf
  v_add_f32_dpp v43, v25, v25 quad_perm:[2,3,0,1] row_mask:0xf bank_mask:0xf
  v_add_f32_dpp v44, v26, v26 quad_perm:[2,3,0,1] row_mask:0xf bank_mask:0xf
  v_add_f32_dpp v45, v27, v27 quad_perm:[2,3,0,1] row_mask:0xf bank_mask:0xf
  v_cndmask_b32_e64 v24, v42, v44, s[88:89]
  v_cndmask_b32_e64 v25, v43, v45, s[88:89]
  s_nop 1
  v_add_f32_dpp v42, v24, v24 quad_perm:[1,0,3,2] row_mask:0xf bank_mask:0xf
  v_add_f32_dpp v43, v25, v25 quad_perm:[1,0,3,2] row_mask:0xf bank_mask:0xf
  v_cndmask_b32_e64 v42, v42, v43, s[86:87]
  v_cvt_pk_bf16_f32 v42, v42, v42
  v_and_b32 v42, 0xffff0000, v42
  v_mul_f32 v42, 0x3db504f3, v42
  v_cvt_pk_bf16_f32 v42, v42, v42
  v_and_b32 v42, 0xffff0000, v42
  v_mov_b32 v43, v42
  s_nop 1
  v_max_f32_dpp v43, v43, v43 row_ror:8 row_mask:0xf bank_mask:0xf
  s_nop 1
  v_max_f32_dpp v43, v43, v43 row_ror:4 row_mask:0xf bank_mask:0xf
  s_nop 1
  v_max_f32_dpp v43, v43, v43 row_ror:2 row_mask:0xf bank_mask:0xf
  s_nop 1
  v_max_f32_dpp v43, v43, v43 row_ror:1 row_mask:0xf bank_mask:0xf
  v_mov_b32 v44, v43
  s_nop 1
  v_permlane16_swap_b32 v43, v44
  s_nop 0
  v_max_f32 v43, v43, v44
  v_mov_b32 v44, v43
  s_nop 1
  v_permlane32_swap_b32 v43, v44
  s_nop 0
  v_max_f32 v43, v43, v44
  v_max_f32 v43, v43, v40
  v_sub_f32 v45, v40, v43
  v_sub_f32 v46, v42, v43
  v_mul_f32 v45, 0x3fb8aa3b, v45
  v_mul_f32 v46, 0x3fb8aa3b, v46
  v_exp_f32 v45, v45
  v_exp_f32 v46, v46
  v_mov_b32 v40, v43
  v_cvt_pk_bf16_f32 v47, v46, v46
  v_fma_f32 v41, v41, v45, v46
  v_mul_f32 v12, v12, v45
  v_mul_f32 v13, v13, v45
  v_mul_f32 v14, v14, v45
  v_mul_f32 v15, v15, v45
  v_and_b32_dpp v16, v47, v8 row_newbcast:0 row_mask:0xf bank_mask:0xf
  v_and_b32_dpp v17, v47, v9 row_newbcast:0 row_mask:0xf bank_mask:0xf
  v_and_b32_dpp v18, v47, v10 row_newbcast:0 row_mask:0xf bank_mask:0xf
  v_and_b32_dpp v19, v47, v11 row_newbcast:0 row_mask:0xf bank_mask:0xf
  v_and_b32_dpp v20, v47, v8 row_newbcast:1 row_mask:0xf bank_mask:0xf
  v_and_b32_dpp v21, v47, v9 row_newbcast:1 row_mask:0xf bank_mask:0xf
  v_and_b32_dpp v22, v47, v10 row_newbcast:1 row_mask:0xf bank_mask:0xf
  v_and_b32_dpp v23, v47, v11 row_newbcast:1 row_mask:0xf bank_mask:0xf
  v_mfma_f32_16x16x32_bf16 v[12:15], v[16:19], a[0:3], v[12:15]
  s_add_u32 s81, s81, 0x10000
  s_and_b32 s81, s81, 0x1fffff
  s_waitcnt vmcnt(15)
  buffer_load_dwordx4 a[0:3], v1, s[48:51], s81 offen nt
  v_and_b32_dpp v16, v47, v8 row_newbcast:2 row_mask:0xf bank_mask:0xf
  v_and_b32_dpp v17, v47, v9 row_newbcast:2 row_mask:0xf bank_mask:0xf
  v_and_b32_dpp v18, v47, v10 row_newbcast:2 row_mask:0xf bank_mask:0xf
  v_and_b32_dpp v19, v47, v11 row_newbcast:2 row_mask:0xf bank_mask:0xf
  v_mfma_f32_16x16x32_bf16 v[12:15], v[20:23], a[4:7], v[12:15]
  s_waitcnt vmcnt(15)
  buffer_load_dwordx4 a[4:7], v1, s[48:51], s81 offen offset:1024 nt
  v_and_b32_dpp v20, v47, v8 row_newbcast:3 row_mask:0xf bank_mask:0xf
  v_and_b32_dpp v21, v47, v9 row_newbcast:3 row_mask:0xf bank_mask:0xf
  v_and_b32_dpp v22, v47, v10 row_newbcast:3 row_mask:0xf bank_mask:0xf
  v_and_b32_dpp v23, v47, v11 row_newbcast:3 row_mask:0xf bank_mask:0xf
  v_mfma_f32_16x16x32_bf16 v[12:15], v[16:19], a[8:11], v[12:15]
  s_waitcnt vmcnt(15)
  buffer_load_dwordx4 a[8:11], v1, s[48:51], s81 offen offset:2048 nt
  v_and_b32_dpp v16, v47, v8 row_newbcast:4 row_mask:0xf bank_mask:0xf
  v_and_b32_dpp v17, v47, v9 row_newbcast:4 row_mask:0xf bank_mask:0xf
  v_and_b32_dpp v18, v47, v10 row_newbcast:4 row_mask:0xf bank_mask:0xf
  v_and_b32_dpp v19, v47, v11 row_newbcast:4 row_mask:0xf bank_mask:0xf
  v_mfma_f32_16x16x32_bf16 v[12:15], v[20:23], a[12:15], v[12:15]
  s_waitcnt vmcnt(15)
  buffer_load_dwordx4 a[12:15], v1, s[48:51], s81 offen offset:3072 nt
  v_and_b32_dpp v20, v47, v8 row_newbcast:5 row_mask:0xf bank_mask:0xf
  v_and_b32_dpp v21, v47, v9 row_newbcast:5 row_mask:0xf bank_mask:0xf
  v_and_b32_dpp v22, v47, v10 row_newbcast:5 row_mask:0xf bank_mask:0xf
  v_and_b32_dpp v23, v47, v11 row_newbcast:5 row_mask:0xf bank_mask:0xf
  v_mfma_f32_16x16x32_bf16 v[12:15], v[16:19], a[16:19], v[12:15]
  s_add_u32 s81, s81, 0x10000
  s_and_b32 s81, s81, 0x1fffff
  s_waitcnt vmcnt(15)
  buffer_load_dwordx4 a[16:19], v1, s[48:51], s81 offen nt
  v_and_b32_dpp v16, v47, v8 row_newbcast:6 row_mask:0xf bank_mask:0xf
  v_and_b32_dpp v17, v47, v9 row_newbcast:6 row_mask:0xf bank_mask:0xf
  v_and_b32_dpp v18, v47, v10 row_newbcast:6 row_mask:0xf bank_mask:0xf
  v_and_b32_dpp v19, v47, v11 row_newbcast:6 row_mask:0xf bank_mask:0xf
  v_mfma_f32_16x16x32_bf16 v[12:15], v[20:23], a[20:23], v[12:15]
  s_waitcnt vmcnt(15)
  buffer_load_dwordx4 a[20:23], v1, s[48:51], s81 offen offset:1024 nt
  v_and_b32_dpp v20, v47, v8 row_newbcast:7 row_mask:0xf bank_mask:0xf
  v_and_b32_dpp v21, v47, v9 row_newbcast:7 row_mask:0xf bank_mask:0xf
  v_and_b32_dpp v22, v47, v10 row_newbcast:7 row_mask:0xf bank_mask:0xf
  v_and_b32_dpp v23, v47, v11 row_newbcast:7 row_mask:0xf bank_mask:0xf
  v_mfma_f32_16x16x32_bf16 v[12:15], v[16:19], a[24:27], v[12:15]
  s_waitcnt vmcnt(15)
  buffer_load_dwordx4 a[24:27], v1, s[48:51], s81 offen offset:2048 nt
  v_and_b32_dpp v16, v47, v8 row_newbcast:8 row_mask:0xf bank_mask:0xf
  v_and_b32_dpp v17, v47, v9 row_newbcast:8 row_mask:0xf bank_mask:0xf
  v_and_b32_dpp v18, v47, v10 row_newbcast:8 row_mask:0xf bank_mask:0xf
  v_and_b32_dpp v19, v47, v11 row_newbcast:8 row_mask:0xf bank_mask:0xf
  v_mfma_f32_16x16x32_bf16 v[12:15], v[20:23], a[28:31], v[12:15]
  s_waitcnt vmcnt(15)
  buffer_load_dwordx4 a[28:31], v1, s[48:51], s81 offen offset:3072 nt
  v_and_b32_dpp v20, v47, v8 row_newbcast:9 row_mask:0xf bank_mask:0xf
  v_and_b32_dpp v21, v47, v9 row_newbcast:9 row_mask:0xf bank_mask:0xf
  v_and_b32_dpp v22, v47, v10 row_newbcast:9 row_mask:0xf bank_mask:0xf
  v_and_b32_dpp v23, v47, v11 row_newbcast:9 row_mask:0xf bank_mask:0xf
  v_mfma_f32_16x16x32_bf16 v[12:15], v[16:19], a[32:35], v[12:15]
  s_add_u32 s81, s81, 0x10000
  s_and_b32 s81, s81, 0x1fffff
  s_waitcnt vmcnt(15)
  buffer_load_dwordx4 a[32:35], v1, s[48:51], s81 offen nt
  v_and_b32_dpp v16, v47, v8 row_newbcast:10 row_mask:0xf bank_mask:0xf
  v_and_b32_dpp v17, v47, v9 row_newbcast:10 row_mask:0xf bank_mask:0xf
  v_and_b32_dpp v18, v47, v10 row_newbcast:10 row_mask:0xf bank_mask:0xf
  v_and_b32_dpp v19, v47, v11 row_newbcast:10 row_mask:0xf bank_mask:0xf
  v_mfma_f32_16x16x32_bf16 v[12:15], v[20:23], a[36:39], v[12:15]
  s_waitcnt vmcnt(15)
  buffer_load_dwordx4 a[36:39], v1, s[48:51], s81 offen offset:1024 nt
  v_and_b32_dpp v20, v47, v8 row_newbcast:11 row_mask:0xf bank_mask:0xf
  v_and_b32_dpp v21, v47, v9 row_newbcast:11 row_mask:0xf bank_mask:0xf
  v_and_b32_dpp v22, v47, v10 row_newbcast:11 row_mask:0xf bank_mask:0xf
  v_and_b32_dpp v23, v47, v11 row_newbcast:11 row_mask:0xf bank_mask:0xf
  v_mfma_f32_16x16x32_bf16 v[12:15], v[16:19], a[40:43], v[12:15]
  s_waitcnt vmcnt(15)
  buffer_load_dwordx4 a[40:43], v1, s[48:51], s81 offen offset:2048 nt
  v_and_b32_dpp v16, v47, v8 row_newbcast:12 row_mask:0xf bank_mask:0xf
  v_and_b32_dpp v17, v47, v9 row_newbcast:12 row_mask:0xf bank_mask:0xf
  v_and_b32_dpp v18, v47, v10 row_newbcast:12 row_mask:0xf bank_mask:0xf
  v_and_b32_dpp v19, v47, v11 row_newbcast:12 row_mask:0xf bank_mask:0xf
  v_mfma_f32_16x16x32_bf16 v[12:15], v[20:23], a[44:47], v[12:15]
  s_waitcnt vmcnt(15)
  buffer_load_dwordx4 a[44:47], v1, s[48:51], s81 offen offset:3072 nt
  v_and_b32_dpp v20, v47, v8 row_newbcast:13 row_mask:0xf bank_mask:0xf
  v_and_b32_dpp v21, v47, v9 row_newbcast:13 row_mask:0xf bank_mask:0xf
  v_and_b32_dpp v22, v47, v10 row_newbcast:13 row_mask:0xf bank_mask:0xf
  v_and_b32_dpp v23, v47, v11 row_newbcast:13 row_mask:0xf bank_mask:0xf
  v_mfma_f32_16x16x32_bf16 v[12:15], v[16:19], a[48:51], v[12:15]
  s_add_u32 s81, s81, 0x10000
  s_and_b32 s81, s81, 0x1fffff
  s_waitcnt vmcnt(15)
  buffer_load_dwordx4 a[48:51], v1, s[48:51], s81 offen nt
  v_and_b32_dpp v16, v47, v8 row_newbcast:14 row_mask:0xf bank_mask:0xf
  v_and_b32_dpp v17, v47, v9 row_newbcast:14 row_mask:0xf bank_mask:0xf
  v_and_b32_dpp v18, v47, v10 row_newbcast:14 row_mask:0xf bank_mask:0xf
  v_and_b32_dpp v19, v47, v11 row_newbcast:14 row_mask:0xf bank_mask:0xf
  v_mfma_f32_16x16x32_bf16 v[12:15], v[20:23], a[52:55], v[12:15]
  s_waitcnt vmcnt(15)
  buffer_load_dwordx4 a[52:55], v1, s[48:51], s81 offen offset:1024 nt
  v_and_b32_dpp v20, v47, v8 row_newbcast:15 row_mask:0xf bank_mask:0xf
  v_and_b32_dpp v21, v47, v9 row_newbcast:15 row_mask:0xf bank_mask:0xf
  v_and_b32_dpp v22, v47, v10 row_newbcast:15 row_mask:0xf bank_mask:0xf
  v_and_b32_dpp v23, v47, v11 row_newbcast:15 row_mask:0xf bank_mask:0xf
  v_mfma_f32_16x16x32_bf16 v[12:15], v[16:19], a[56:59], v[12:15]
  s_waitcnt vmcnt(15)
  buffer_load_dwordx4 a[56:59], v1, s[48:51], s81 offen offset:2048 nt
  s_nop 1
  v_mfma_f32_16x16x32_bf16 v[12:15], v[20:23], a[60:63], v[12:15]
  s_waitcnt vmcnt(15)
  buffer_load_dwordx4 a[60:63], v1, s[48:51], s81 offen offset:3072 nt
  v_dot2_f32_bf16 v24, v64, v4, 0
  v_dot2_f32_bf16 v24, v65, v5, v24
  v_dot2_f32_bf16 v24, v66, v6, v24
  v_dot2_f32_bf16 v24, v67, v7, v24
  v_dot2_f32_bf16 v25, v68, v4, 0
  v_dot2_f32_bf16 v25, v69, v5, v25
  v_dot2_f32_bf16 v25, v70, v6, v25
  v_dot2_f32_bf16 v25, v71, v7, v25
  v_dot2_f32_bf16 v26, v72, v4, 0
  v_dot2_f32_bf16 v26, v73, v5, v26
  v_dot2_f32_bf16 v26, v74, v6, v26
  v_dot2_f32_bf16 v26, v75, v7, v26
  v_xor_b32 v240, s23, v240
  v_xor_b32 v242, s23, v242
  v_or_b32 v240, v240, v242
  v_cmp_ne_u32 vcc, 0, v240
  s_mov_b32 s83, 20000
  s_mov_b32 s10, 0xc1000
  s_cbranch_vccz L_voteok_4
L_votelp_5:
  buffer_load_dwordx4 v[240:243], v1, s[60:63], s10 offen sc1
  s_waitcnt vmcnt(0)
  v_xor_b32 v240, s23, v240
  v_xor_b32 v242, s23, v242
  v_or_b32 v240, v240, v242
  v_cmp_ne_u32 vcc, 0, v240
  s_sub_u32 s83, s83, 1
  s_cbranch_scc1 L_voteok_4
  s_nop 0
  s_cbranch_vccnz L_votelp_5
L_voteok_4:
  v_cmp_gt_u32 vcc, v241, v243
  s_nop 2
  s_bcnt1_i32_b64 s13, vcc
  s_cmp_gt_u32 s13, 32
  s_cselect_b32 s10, 0x2000, 0
  s_add_u32 s60, s60, s10
  s_addc_u32 s61, s61, 0
  v_dot2_f32_bf16 v27, v76, v4, 0
  v_dot2_f32_bf16 v27, v77, v5, v27
  v_dot2_f32_bf16 v27, v78, v6, v27
  v_dot2_f32_bf16 v27, v79, v7, v27
  v_dot2_f32_bf16 v28, v80, v4, 0
  v_dot2_f32_bf16 v28, v81, v5, v28
  v_dot2_f32_bf16 v28, v82, v6, v28
  v_dot2_f32_bf16 v28, v83, v7, v28
  s_branch L_over_4
L_stub_4:
  s_branch L_back_1
L_over_4:
  v_dot2_f32_bf16 v29, v84, v4, 0
  v_dot2_f32_bf16 v29, v85, v5, v29
  v_dot2_f32_bf16 v29, v86, v6, v29
  v_dot2_f32_bf16 v29, v87, v7, v29
  v_dot2_f32_bf16 v30, v88, v4, 0
  v_dot2_f32_bf16 v30, v89, v5, v30
  v_dot2_f32_bf16 v30, v90, v6, v30
  v_dot2_f32_bf16 v30, v91, v7, v30
  v_dot2_f32_bf16 v31, v92, v4, 0
  v_dot2_f32_bf16 v31, v93, v5, v31
  v_dot2_f32_bf16 v31, v94, v6, v31
  v_dot2_f32_bf16 v31, v95, v7, v31
  v_dot2_f32_bf16 v32, v96, v4, 0
  v_dot2_f32_bf16 v32, v97, v5, v32
  v_dot2_f32_bf16 v32, v98, v6, v32
  v_dot2_f32_bf16 v32, v99, v7, v32
  v_dot2_f32_bf16 v33, v100, v4, 0
  v_dot2_f32_bf16 v33, v101, v5, v33
  v_dot2_f32_bf16 v33, v102, v6, v33
  v_dot2_f32_bf16 v33, v103, v7, v33
  v_dot2_f32_bf16 v34, v104, v4, 0
  v_dot2_f32_bf16 v34, v105, v5, v34
  v_dot2_f32_bf16 v34, v106, v6, v34
  v_dot2_f32_bf16 v34, v107, v7, v34
  v_dot2_f32_bf16 v35, v108, v4, 0
  v_dot2_f32_bf16 v35, v109, v5, v35
  v_dot2_f32_bf16 v35, v110, v6, v35
  v_dot2_f32_bf16 v35, v111, v7, v35
  v_dot2_f32_bf16 v36, v112, v4, 0
  v_dot2_f32_bf16 v36, v113, v5, v36
  v_dot2_f32_bf16 v36, v114, v6, v36
  v_dot2_f32_bf16 v36, v115, v7, v36
  v_dot2_f32_bf16 v37, v116, v4, 0
  v_dot2_f32_bf16 v37, v117, v5, v37
  v_dot2_f32_bf16 v37, v118, v6, v37
  v_dot2_f32_bf16 v37, v119, v7, v37
  v_dot2_f32_bf16 v38, v120, v4, 0
  v_dot2_f32_bf16 v38, v121, v5, v38
  v_dot2_f32_bf16 v38, v122, v6, v38
  v_dot2_f32_bf16 v38, v123, v7, v38
  v_dot2_f32_bf16 v39, v124, v4, 0
  v_dot2_f32_bf16 v39, v125, v5, v39
  v_dot2_f32_bf16 v39, v126, v6, v39
  v_dot2_f32_bf16 v39, v127, v7, v39
  s_nop 2
  v_add_f32_dpp v24, v24, v24 row_ror:8 row_mask:0xf bank_mask:0x3
  v_add_f32_dpp v25, v25, v25 row_ror:8 row_mask:0xf bank_mask:0x3
  v_add_f32_dpp v26, v26, v26 row_ror:8 row_mask:0xf bank_mask:0x3
  v_add_f32_dpp v27, v27, v27 row_ror:8 row_mask:0xf bank_mask:0x3
  v_add_f32_dpp v28, v28, v28 row_ror:8 row_mask:0xf bank_mask:0x3
  v_add_f32_dpp v29, v29, v29 row_ror:8 row_mask:0xf bank_mask:0x3
  v_add_f32_dpp v30, v30, v30 row_ror:8 row_mask:0xf bank_mask:0x3
  v_add_f32_dpp v31, v31, v31 row_ror:8 row_mask:0xf bank_mask:0x3
  v_add_f32_dpp v24, v32, v32 row_ror:8 row_mask:0xf bank_mask:0xc
  v_add_f32_dpp v25, v33, v33 row_ror:8 row_mask:0xf bank_mask:0xc
  v_add_f32_dpp v26, v34, v34 row_ror:8 row_mask:0xf bank_mask:0xc
  v_add_f32_dpp v27, v35, v35 row_ror:8 row_mask:0xf bank_mask:0xc
  v_add_f32_dpp v28, v36, v36 row_ror:8 row_mask:0xf bank_mask:0xc
  v_add_f32_dpp v29, v37, v37 row_ror:8 row_mask:0xf bank_mask:0xc
  v_add_f32_dpp v30, v38, v38 row_ror:8 row_mask:0xf bank_mask:0xc
  v_add_f32_dpp v31, v39, v39 row_ror:8 row_mask:0xf bank_mask:0xc
  v_add_f32_dpp v24, v24, v24 row_shl:4 row_mask:0xf bank_mask:0x5
  v_add_f32_dpp v25, v25, v25 row_shl:4 row_mask:0xf bank_mask:0x5
  v_add_f32_dpp v26, v26, v26 row_shl:4 row_mask:0xf bank_mask:0x5
  v_add_f32_dpp v27, v27, v27 row_shl:4 row_mask:0xf bank_mask:0x5
  v_add_f32_dpp v24, v28, v28 row_shr:4 row_mask:0xf bank_mask:0xa
  v_add_f32_dpp v25, v29, v29 row_shr:4 row_mask:0xf bank_mask:0xa
  v_add_f32_dpp v26, v30, v30 row_shr:4 row_mask:0xf bank_mask:0xa
  v_add_f32_dpp v27, v31, v31 row_shr:4 row_mask:0xf bank_mask:0xa
  s_nop 0
  v_add_f32_dpp v42, v24, v24 quad_perm:[2,3,0,1] row_mask:0xf bank_mask:0xf
  v_add_f32_dpp v43, v25, v25 quad_perm:[2,3,0,1] row_mask:0xf bank_mask:0xf
  v_add_f32_dpp v44, v26, v26 quad_perm:[2,3,0,1] row_mask:0xf bank_mask:0xf
  v_add_f32_dpp v45, v27, v27 quad_perm:[2,3,0,1] row_mask:0xf bank_mask:0xf
  v_cndmask_b32_e64 v24, v42, v44, s[88:89]
  v_cndmask_b32_e64 v25, v43, v45, s[88:89]
  s_nop 1
  v_add_f32_dpp v42, v24, v24 quad_perm:[1,0,3,2] row_mask:0xf bank_mask:0xf
  v_add_f32_dpp v43, v25, v25 quad_perm:[1,0,3,2] row_mask:0xf bank_mask:0xf
  v_cndmask_b32_e64 v42, v42, v43, s[86:87]
  v_cvt_pk_bf16_f32 v42, v42, v42
  v_and_b32 v42, 0xffff0000, v42
  v_mul_f32 v42, 0x3db504f3, v42
  v_cvt_pk_bf16_f32 v42, v42, v42
  v_and_b32 v42, 0xffff0000, v42
  v_mov_b32 v43, v42
  s_nop 1
  v_max_f32_dpp v43, v43, v43 row_ror:8 row_mask:0xf bank_mask:0xf
  s_nop 1
  v_max_f32_dpp v43, v43, v43 row_ror:4 row_mask:0xf bank_mask:0xf
  s_nop 1
  v_max_f32_dpp v43, v43, v43 row_ror:2 row_mask:0xf bank_mask:0xf
  s_nop 1
  v_max_f32_dpp v43, v43, v43 row_ror:1 row_mask:0xf bank_mask:0xf
  v_mov_b32 v44, v43
  s_nop 1
  v_permlane16_swap_b32 v43, v44
  s_nop 0
  v_max_f32 v43, v43, v44
  v_mov_b32 v44, v43
  s_nop 1
  v_permlane32_swap_b32 v43, v44
  s_nop 0
  v_max_f32 v43, v43, v44
  v_max_f32 v43, v43, v40
  v_sub_f32 v45, v40, v43
  v_sub_f32 v46, v42, v43
  v_mul_f32 v45, 0x3fb8aa3b, v45
  v_mul_f32 v46, 0x3fb8aa3b, v46
  v_exp_f32 v45, v45
  v_exp_f32 v46, v46
  v_mov_b32 v40, v43
  v_cvt_pk_bf16_f32 v47, v46, v46
  v_fma_f32 v41, v41, v45, v46
  v_mul_f32 v12, v12, v45
  v_mul_f32 v13, v13, v45
  v_mul_f32 v14, v14, v45
  v_mul_f32 v15, v15, v45
  s_nop 1
  v_add_f32_dpp v41, v41, v41 row_ror:8 row_mask:0xf bank_mask:0xf
  s_nop 1
  v_add_f32_dpp v41, v41, v41 row_ror:4 row_mask:0xf bank_mask:0xf
  s_nop 1
  v_add_f32_dpp v41, v41, v41 row_ror:2 row_mask:0xf bank_mask:0xf
  s_nop 1
  v_add_f32_dpp v41, v41, v41 row_ror:1 row_mask:0xf bank_mask:0xf
  v_mov_b32 v48, v41
  s_nop 1
  v_permlane16_swap_b32 v41, v48
  s_nop 0
  v_add_f32 v41, v41, v48
  v_mov_b32 v48, v41
  s_nop 1
  v_permlane32_swap_b32 v41, v48
  s_nop 0
  v_add_f32 v41, v41, v48
  v_and_b32_dpp v16, v47, v8 row_newbcast:0 row_mask:0xf bank_mask:0xf
  v_and_b32_dpp v17, v47, v9 row_newbcast:0 row_mask:0xf bank_mask:0xf
  v_and_b32_dpp v18, v47, v10 row_newbcast:0 row_mask:0xf bank_mask:0xf
  v_and_b32_dpp v19, v47, v11 row_newbcast:0 row_mask:0xf bank_mask:0xf
  v_and_b32_dpp v20, v47, v8 row_newbcast:1 row_mask:0xf bank_mask:0xf
  v_and_b32_dpp v21, v47, v9 row_newbcast:1 row_mask:0xf bank_mask:0xf
  v_and_b32_dpp v22, v47, v10 row_newbcast:1 row_mask:0xf bank_mask:0xf
  v_and_b32_dpp v23, v47, v11 row_newbcast:1 row_mask:0xf bank_mask:0xf
  s_waitcnt vmcnt(15)
  v_mfma_f32_16x16x32_bf16 v[12:15], v[16:19], a[0:3], v[12:15]
  v_and_b32_dpp v16, v47, v8 row_newbcast:2 row_mask:0xf bank_mask:0xf
  v_and_b32_dpp v17, v47, v9 row_newbcast:2 row_mask:0xf bank_mask:0xf
  v_and_b32_dpp v18, v47, v10 row_newbcast:2 row_mask:0xf bank_mask:0xf
  v_and_b32_dpp v19, v47, v11 row_newbcast:2 row_mask:0xf bank_mask:0xf
  s_waitcnt vmcnt(14)
  v_mfma_f32_16x16x32_bf16 v[12:15], v[20:23], a[4:7], v[12:15]
  v_and_b32_dpp v20, v47, v8 row_newbcast:3 row_mask:0xf bank_mask:0xf
  v_and_b32_dpp v21, v47, v9 row_newbcast:3 row_mask:0xf bank_mask:0xf
  v_and_b32_dpp v22, v47, v10 row_newbcast:3 row_mask:0xf bank_mask:0xf
  v_and_b32_dpp v23, v47, v11 row_newbcast:3 row_mask:0xf bank_mask:0xf
  s_waitcnt vmcnt(13)
  v_mfma_f32_16x16x32_bf16 v[12:15], v[16:19], a[8:11], v[12:15]
  v_and_b32_dpp v16, v47, v8 row_newbcast:4 row_mask:0xf bank_mask:0xf
  v_and_b32_dpp v17, v47, v9 row_newbcast:4 row_mask:0xf bank_mask:0xf
  v_and_b32_dpp v18, v47, v10 row_newbcast:4 row_mask:0xf bank_mask:0xf
  v_and_b32_dpp v19, v47, v11 row_newbcast:4 row_mask:0xf bank_mask:0xf
  s_waitcnt vmcnt(12)
  v_mfma_f32_16x16x32_bf16 v[12:15], v[20:23], a[12:15], v[12:15]
  v_and_b32_dpp v20, v47, v8 row_newbcast:5 row_mask:0xf bank_mask:0xf
  v_and_b32_dpp v21, v47, v9 row_newbcast:5 row_mask:0xf bank_mask:0xf
  v_and_b32_dpp v22, v47, v10 row_newbcast:5 row_mask:0xf bank_mask:0xf
  v_and_b32_dpp v23, v47, v11 row_newbcast:5 row_mask:0xf bank_mask:0xf
  s_waitcnt vmcnt(11)
  v_mfma_f32_16x16x32_bf16 v[12:15], v[16:19], a[16:19], v[12:15]
  s_lshl_b32 s10, s3, 14
  s_add_u32 m0, s10, 0
  s_mov_b32 s11, 0
  buffer_load_dwordx4 v197, s[64:67], s11 offen nt lds
  v_and_b32_dpp v16, v47, v8 row_newbcast:6 row_mask:0xf bank_mask:0xf
  v_and_b32_dpp v17, v47, v9 row_newbcast:6 row_mask:0xf bank_mask:0xf
  v_and_b32_dpp v18, v47, v10 row_newbcast:6 row_mask:0xf bank_mask:0xf
  v_and_b32_dpp v19, v47, v11 row_newbcast:6 row_mask:0xf bank_mask:0xf
  s_waitcnt vmcnt(11)
  v_mfma_f32_16x16x32_bf16 v[12:15], v[20:23], a[20:23], v[12:15]
  s_lshl_b32 s10, s3, 14
  s_add_u32 m0, s10, 1024
  s_mov_b32 s11, 28672
  buffer_load_dwordx4 v198, s[64:67], s11 offen nt lds
  v_and_b32_dpp v20, v47, v8 row_newbcast:7 row_mask:0xf bank_mask:0xf
  v_and_b32_dpp v21, v47, v9 row_newbcast:7 row_mask:0xf bank_mask:0xf
  v_and_b32_dpp v22, v47, v10 row_newbcast:7 row_mask:0xf bank_mask:0xf
  v_and_b32_dpp v23, v47, v11 row_newbcast:7 row_mask:0xf bank_mask:0xf
  s_waitcnt vmcnt(11)
  v_mfma_f32_16x16x32_bf16 v[12:15], v[16:19], a[24:27], v[12:15]
  s_lshl_b32 s10, s3, 14
  s_add_u32 m0, s10, 2048
  s_mov_b32 s11, 57344
  buffer_load_dwordx4 v197, s[64:67], s11 offen nt lds
  v_and_b32_dpp v16, v47, v8 row_newbcast:8 row_mask:0xf bank_mask:0xf
  v_and_b32_dpp v17, v47, v9 row_newbcast:8 row_mask:0xf bank_mask:0xf
  v_and_b32_dpp v18, v47, v10 row_newbcast:8 row_mask:0xf bank_mask:0xf
  v_and_b32_dpp v19, v47, v11 row_newbcast:8 row_mask:0xf bank_mask:0xf
  s_waitcnt vmcnt(11)
  v_mfma_f32_16x16x32_bf16 v[12:15], v[20:23], a[28:31], v[12:15]
  s_lshl_b32 s10, s3, 14
  s_add_u32 m0, s10, 3072
  s_mov_b32 s11, 86016
  buffer_load_dwordx4 v198, s[64:67], s11 offen nt lds
  v_and_b32_dpp v20, v47, v8 row_newbcast:9 row_mask:0xf bank_mask:0xf
  v_and_b32_dpp v21, v47, v9 row_newbcast:9 row_mask:0xf bank_mask:0xf
  v_and_b32_dpp v22, v47, v10 row_newbcast:9 row_mask:0xf bank_mask:0xf
  v_and_b32_dpp v23, v47, v11 row_newbcast:9 row_mask:0xf bank_mask:0xf
  s_waitcnt vmcnt(11)
  v_mfma_f32_16x16x32_bf16 v[12:15], v[16:19], a[32:35], v[12:15]
  s_lshl_b32 s10, s3, 14
  s_add_u32 m0, s10, 4096
  s_mov_b32 s11, 114688
  buffer_load_dwordx4 v197, s[64:67], s11 offen nt lds
  v_and_b32_dpp v16, v47, v8 row_newbcast:10 row_mask:0xf bank_mask:0xf
  v_and_b32_dpp v17, v47, v9 row_newbcast:10 row_mask:0xf bank_mask:0xf
  v_and_b32_dpp v18, v47, v10 row_newbcast:10 row_mask:0xf bank_mask:0xf
  v_and_b32_dpp v19, v47, v11 row_newbcast:10 row_mask:0xf bank_mask:0xf
  s_waitcnt vmcnt(11)
  v_mfma_f32_16x16x32_bf16 v[12:15], v[20:23], a[36:39], v[12:15]
  s_lshl_b32 s10, s3, 14
  s_add_u32 m0, s10, 5120
  s_mov_b32 s11, 143360
  buffer_load_dwordx4 v198, s[64:67], s11 offen nt lds
  v_and_b32_dpp v20, v47, v8 row_newbcast:11 row_mask:0xf bank_mask:0xf
  v_and_b32_dpp v21, v47, v9 row_newbcast:11 row_mask:0xf bank_mask:0xf
  v_and_b32_dpp v22, v47, v10 row_newbcast:11 row_mask:0xf bank_mask:0xf
  v_and_b32_dpp v23, v47, v11 row_newbcast:11 row_mask:0xf bank_mask:0xf
  s_waitcnt vmcnt(11)
  v_mfma_f32_16x16x32_bf16 v[12:15], v[16:19], a[40:43], v[12:15]
  s_lshl_b32 s10, s3, 14
  s_add_u32 m0, s10, 6144
  s_mov_b32 s11, 172032
  buffer_load_dwordx4 v197, s[64:67], s11 offen nt lds
  v_and_b32_dpp v16, v47, v8 row_newbcast:12 row_mask:0xf bank_mask:0xf
  v_and_b32_dpp v17, v47, v9 row_newbcast:12 row_mask:0xf bank_mask:0xf
  v_and_b32_dpp v18, v47, v10 row_newbcast:12 row_mask:0xf bank_mask:0xf
  v_and_b32_dpp v19, v47, v11 row_newbcast:12 row_mask:0xf bank_mask:0xf
  s_waitcnt vmcnt(11)
  v_mfma_f32_16x16x32_bf16 v[12:15], v[20:23], a[44:47], v[12:15]
  s_lshl_b32 s10, s3, 14
  s_add_u32 m0, s10, 7168
  s_mov_b32 s11, 200704
  buffer_load_dwordx4 v198, s[64:67], s11 offen nt lds
  v_and_b32_dpp v20, v47, v8 row_newbcast:13 row_mask:0xf bank_mask:0xf
  v_and_b32_dpp v21, v47, v9 row_newbcast:13 row_mask:0xf bank_mask:0xf
  v_and_b32_dpp v22, v47, v10 row_newbcast:13 row_mask:0xf bank_mask:0xf
  v_and_b32_dpp v23, v47, v11 row_newbcast:13 row_mask:0xf bank_mask:0xf
  s_waitcnt vmcnt(11)
  v_mfma_f32_16x16x32_bf16 v[12:15], v[16:19], a[48:51], v[12:15]
  s_lshl_b32 s10, s3, 14
  s_add_u32 m0, s10, 8192
  s_mov_b32 s11, 229376
  buffer_load_dwordx4 v197, s[64:67], s11 offen nt lds
  v_and_b32_dpp v16, v47, v8 row_newbcast:14 row_mask:0xf bank_mask:0xf
  v_and_b32_dpp v17, v47, v9 row_newbcast:14 row_mask:0xf bank_mask:0xf
  v_and_b32_dpp v18, v47, v10 row_newbcast:14 row_mask:0xf bank_mask:0xf
  v_and_b32_dpp v19, v47, v11 row_newbcast:14 row_mask:0xf bank_mask:0xf
  s_waitcnt vmcnt(11)
  v_mfma_f32_16x16x32_bf16 v[12:15], v[20:23], a[52:55], v[12:15]
  s_lshl_b32 s10, s3, 14
  s_add_u32 m0, s10, 9216
  s_mov_b32 s11, 258048
  buffer_load_dwordx4 v198, s[64:67], s11 offen nt lds
  v_and_b32_dpp v20, v47, v8 row_newbcast:15 row_mask:0xf bank_mask:0xf
  v_and_b32_dpp v21, v47, v9 row_newbcast:15 row_mask:0xf bank_mask:0xf
  v_and_b32_dpp v22, v47, v10 row_newbcast:15 row_mask:0xf bank_mask:0xf
  v_and_b32_dpp v23, v47, v11 row_newbcast:15 row_mask:0xf bank_mask:0xf
  s_waitcnt vmcnt(11)
  v_mfma_f32_16x16x32_bf16 v[12:15], v[16:19], a[56:59], v[12:15]
  s_lshl_b32 s10, s3, 14
  s_add_u32 m0, s10, 10240
  s_mov_b32 s11, 286720
  buffer_load_dwordx4 v197, s[64:67], s11 offen nt lds
  s_nop 1
  s_waitcnt vmcnt(11)
  v_mfma_f32_16x16x32_bf16 v[12:15], v[20:23], a[60:63], v[12:15]
  s_lshl_b32 s10, s3, 14
  s_add_u32 m0, s10, 11264
  s_mov_b32 s11, 315392
  buffer_load_dwordx4 v198, s[64:67], s11 offen nt lds
  v_lshrrev_b32 v42, 4, v2
  v_and_b32 v43, 15, v2
  v_lshlrev_b32 v44, 5, v43
  v_lshl_or_b32 v44, v42, 4, v44
  s_lshl_b32 s10, s3, 9
  s_add_u32 s10, s10, 75776
  v_add_u32 v44, s10, v44
  s_lshl_b32 s10, s3, 3
  s_add_u32 s10, s10, 77824
  v_mov_b32 v45, s10
  s_nop 3
  s_mov_b32 exec_lo, 0xffffffff
  s_mov_b32 exec_hi, 0x0
  ds_write_b128 v44, v[12:15]
  s_mov_b32 exec_lo, 0x1
  s_mov_b32 exec_hi, 0x0
  ds_write_b64 v45, v[40:41]
  s_mov_b64 exec, -1
  v_lshlrev_b32 v44, 4, v43
  v_lshl_or_b32 v44, v42, 2, v44
  v_add_u32 v44, 75776, v44
  v_mov_b32 v45, 77824
  s_waitcnt lgkmcnt(0)
  s_barrier
  ds_read_b128 v[24:27], v45
  ds_read_b128 v[28:31], v45 offset:16
  ds_read_b32 v32, v44 offset:0
  ds_read_b32 v33, v44 offset:256
  ds_read_b32 v34, v44 offset:512
  ds_read_b32 v35, v44 offset:768
  ds_read_b32 v36, v44 offset:1024
  ds_read_b32 v37, v44 offset:1280
  ds_read_b32 v38, v44 offset:1536
  ds_read_b32 v39, v44 offset:1792
  v_bfe_u32 v50, v2, 2, 3
  v_and_b32 v51, 1, v50
  v_lshlrev_b32 v51, 2, v51
  v_and_or_b32 v51, v50, 2, v51
  v_lshrrev_b32 v50, 2, v50
  v_or_b32 v50, v50, v51
  v_lshlrev_b32 v50, 13, v50
  v_and_b32 v51, 3, v2
  v_lshl_or_b32 v50, v51, 4, v50
  s_lshl_b32 s10, s6, 2
  s_add_u32 s10, s10, s3
  s_lshl_b32 s10, s10, 16
  s_lshl_b32 s11, s9, 6
  s_add_u32 s10, s10, s11
  v_add_u32 v50, s10, v50
  s_lshl_b32 s10, s6, 7
  s_add_u32 s10, s10, s9
  s_lshl_b32 s10, s10, 4
  s_add_u32 s10, s10, 655360
  v_lshlrev_b32 v52, 13, v2
  v_add_u32 v52, s10, v52
  s_waitcnt lgkmcnt(8)
  v_max_f32 v46, v24, v26
  v_max3_f32 v46, v46, v28, v30
  v_sub_f32 v24, v24, v46
  v_sub_f32 v26, v26, v46
  v_sub_f32 v28, v28, v46
  v_sub_f32 v30, v30, v46
  v_mul_f32 v24, 0x3fb8aa3b, v24
  v_mul_f32 v26, 0x3fb8aa3b, v26
  v_mul_f32 v28, 0x3fb8aa3b, v28
  v_mul_f32 v30, 0x3fb8aa3b, v30
  v_exp_f32 v24, v24
  v_exp_f32 v26, v26
  v_exp_f32 v28, v28
  v_exp_f32 v30, v30
  v_mul_f32 v47, v24, v25
  v_fma_f32 v47, v26, v27, v47
  v_fma_f32 v47, v28, v29, v47
  v_fma_f32 v47, v30, v31, v47
  v_and_b32 v54, 0xffff0000, v46
  v_or_b32 v54, s22, v54
  v_add_u32 v55, 0x200, v47
  v_and_b32 v55, 0xfffffc00, v55
  v_or_b32 v55, s19, v55
  v_mov_b32 v56, s23
  v_mov_b32 v57, s23
  s_cmp_lg_u32 s3, 0
  s_cbranch_scc1 L_noml_6
  s_mov_b32 exec_lo, 0x3
  s_mov_b32 exec_hi, 0x0
  buffer_store_dwordx4 v[54:57], v52, s[60:63], 0 offen sc1
  s_mov_b64 exec, -1
L_noml_6:
  s_waitcnt lgkmcnt(0)
  v_mul_f32 v48, v24, v32
  v_mul_f32 v49, v24, v33
  v_fma_f32 v48, v26, v34, v48
  v_fma_f32 v49, v26, v35, v49
  v_fma_f32 v48, v28, v36, v48
  v_fma_f32 v49, v28, v37, v49
  v_fma_f32 v48, v30, v38, v48
  v_fma_f32 v49, v30, v39, v49
  v_cvt_pk_bf16_f32 v48, v48, v48
  v_cvt_pk_bf16_f32 v49, v49, v49
  s_nop 1
  v_and_b32_dpp v16, v48, v8 row_newbcast:0 row_mask:0xf bank_mask:0xf
  v_and_b32_dpp v17, v48, v9 row_newbcast:0 row_mask:0xf bank_mask:0xf
  v_and_b32_dpp v18, v48, v10 row_newbcast:0 row_mask:0xf bank_mask:0xf
  v_and_b32_dpp v19, v48, v11 row_newbcast:0 row_mask:0xf bank_mask:0xf
  v_and_b32_dpp v20, v48, v8 row_newbcast:1 row_mask:0xf bank_mask:0xf
  v_and_b32_dpp v21, v48, v9 row_newbcast:1 row_mask:0xf bank_mask:0xf
  v_and_b32_dpp v22, v48, v10 row_newbcast:1 row_mask:0xf bank_mask:0xf
  v_and_b32_dpp v23, v48, v11 row_newbcast:1 row_mask:0xf bank_mask:0xf
  v_mfma_f32_16x16x32_bf16 v[12:15], v[16:19], a[64:67], 0
  v_and_b32_dpp v16, v48, v8 row_newbcast:2 row_mask:0xf bank_mask:0xf
  v_and_b32_dpp v17, v48, v9 row_newbcast:2 row_mask:0xf bank_mask:0xf
  v_and_b32_dpp v18, v48, v10 row_newbcast:2 row_mask:0xf bank_mask:0xf
  v_and_b32_dpp v19, v48, v11 row_newbcast:2 row_mask:0xf bank_mask:0xf
  v_mfma_f32_16x16x32_bf16 v[12:15], v[20:23], a[68:71], v[12:15]
  v_and_b32_dpp v20, v48, v8 row_newbcast:3 row_mask:0xf bank_mask:0xf
  v_and_b32_dpp v21, v48, v9 row_newbcast:3 row_mask:0xf bank_mask:0xf
  v_and_b32_dpp v22, v48, v10 row_newbcast:3 row_mask:0xf bank_mask:0xf
  v_and_b32_dpp v23, v48, v11 row_newbcast:3 row_mask:0xf bank_mask:0xf
  v_mfma_f32_16x16x32_bf16 v[12:15], v[16:19], a[72:75], v[12:15]
  v_and_b32_dpp v16, v48, v8 row_newbcast:4 row_mask:0xf bank_mask:0xf
  v_and_b32_dpp v17, v48, v9 row_newbcast:4 row_mask:0xf bank_mask:0xf
  v_and_b32_dpp v18, v48, v10 row_newbcast:4 row_mask:0xf bank_mask:0xf
  v_and_b32_dpp v19, v48, v11 row_newbcast:4 row_mask:0xf bank_mask:0xf
  v_mfma_f32_16x16x32_bf16 v[12:15], v[20:23], a[76:79], v[12:15]
  v_and_b32_dpp v20, v48, v8 row_newbcast:5 row_mask:0xf bank_mask:0xf
  v_and_b32_dpp v21, v48, v9 row_newbcast:5 row_mask:0xf bank_mask:0xf
  v_and_b32_dpp v22, v48, v10 row_newbcast:5 row_mask:0xf bank_mask:0xf
  v_and_b32_dpp v23, v48, v11 row_newbcast:5 row_mask:0xf bank_mask:0xf
  v_mfma_f32_16x16x32_bf16 v[12:15], v[16:19], a[80:83], v[12:15]
  v_and_b32_dpp v16, v48, v8 row_newbcast:6 row_mask:0xf bank_mask:0xf
  v_and_b32_dpp v17, v48, v9 row_newbcast:6 row_mask:0xf bank_mask:0xf
  v_and_b32_dpp v18, v48, v10 row_newbcast:6 row_mask:0xf bank_mask:0xf
  v_and_b32_dpp v19, v48, v11 row_newbcast:6 row_mask:0xf bank_mask:0xf
  v_mfma_f32_16x16x32_bf16 v[12:15], v[20:23], a[84:87], v[12:15]
  v_and_b32_dpp v20, v48, v8 row_newbcast:7 row_mask:0xf bank_mask:0xf
  v_and_b32_dpp v21, v48, v9 row_newbcast:7 row_mask:0xf bank_mask:0xf
  v_and_b32_dpp v22, v48, v10 row_newbcast:7 row_mask:0xf bank_mask:0xf
  v_and_b32_dpp v23, v48, v11 row_newbcast:7 row_mask:0xf bank_mask:0xf
  v_mfma_f32_16x16x32_bf16 v[12:15], v[16:19], a[88:91], v[12:15]
  v_and_b32_dpp v16, v48, v8 row_newbcast:8 row_mask:0xf bank_mask:0xf
  v_and_b32_dpp v17, v48, v9 row_newbcast:8 row_mask:0xf bank_mask:0xf
  v_and_b32_dpp v18, v48, v10 row_newbcast:8 row_mask:0xf bank_mask:0xf
  v_and_b32_dpp v19, v48, v11 row_newbcast:8 row_mask:0xf bank_mask:0xf
  v_mfma_f32_16x16x32_bf16 v[12:15], v[20:23], a[92:95], v[12:15]
  v_and_b32_dpp v20, v48, v8 row_newbcast:9 row_mask:0xf bank_mask:0xf
  v_and_b32_dpp v21, v48, v9 row_newbcast:9 row_mask:0xf bank_mask:0xf
  v_and_b32_dpp v22, v48, v10 row_newbcast:9 row_mask:0xf bank_mask:0xf
  v_and_b32_dpp v23, v48, v11 row_newbcast:9 row_mask:0xf bank_mask:0xf
  v_mfma_f32_16x16x32_bf16 v[12:15], v[16:19], a[96:99], v[12:15]
  v_and_b32_dpp v16, v48, v8 row_newbcast:10 row_mask:0xf bank_mask:0xf
  v_and_b32_dpp v17, v48, v9 row_newbcast:10 row_mask:0xf bank_mask:0xf
  v_and_b32_dpp v18, v48, v10 row_newbcast:10 row_mask:0xf bank_mask:0xf
  v_and_b32_dpp v19, v48, v11 row_newbcast:10 row_mask:0xf bank_mask:0xf
  v_mfma_f32_16x16x32_bf16 v[12:15], v[20:23], a[100:103], v[12:15]
  v_and_b32_dpp v20, v48, v8 row_newbcast:11 row_mask:0xf bank_mask:0xf
  v_and_b32_dpp v21, v48, v9 row_newbcast:11 row_mask:0xf bank_mask:0xf
  v_and_b32_dpp v22, v48, v10 row_newbcast:11 row_mask:0xf bank_mask:0xf
  v_and_b32_dpp v23, v48, v11 row_newbcast:11 row_mask:0xf bank_mask:0xf
  v_mfma_f32_16x16x32_bf16 v[12:15], v[16:19], a[104:107], v[12:15]
  v_and_b32_dpp v16, v48, v8 row_newbcast:12 row_mask:0xf bank_mask:0xf
  v_and_b32_dpp v17, v48, v9 row_newbcast:12 row_mask:0xf bank_mask:0xf
  v_and_b32_dpp v18, v48, v10 row_newbcast:12 row_mask:0xf bank_mask:0xf
  v_and_b32_dpp v19, v48, v11 row_newbcast:12 row_mask:0xf bank_mask:0xf
  v_mfma_f32_16x16x32_bf16 v[12:15], v[20:23], a[108:111], v[12:15]
  v_and_b32_dpp v20, v48, v8 row_newbcast:13 row_mask:0xf bank_mask:0xf
  v_and_b32_dpp v21, v48, v9 row_newbcast:13 row_mask:0xf bank_mask:0xf
  v_and_b32_dpp v22, v48, v10 row_newbcast:13 row_mask:0xf bank_mask:0xf
  v_and_b32_dpp v23, v48, v11 row_newbcast:13 row_mask:0xf bank_mask:0xf
  v_mfma_f32_16x16x32_bf16 v[12:15], v[16:19], a[112:115], v[12:15]
  v_and_b32_dpp v16, v48, v8 row_newbcast:14 row_mask:0xf bank_mask:0xf
  v_and_b32_dpp v17, v48, v9 row_newbcast:14 row_mask:0xf bank_mask:0xf
  v_and_b32_dpp v18, v48, v10 row_newbcast:14 row_mask:0xf bank_mask:0xf
  v_and_b32_dpp v19, v48, v11 row_newbcast:14 row_mask:0xf bank_mask:0xf
  v_mfma_f32_16x16x32_bf16 v[12:15], v[20:23], a[116:119], v[12:15]
  v_and_b32_dpp v20, v48, v8 row_newbcast:15 row_mask:0xf bank_mask:0xf
  v_and_b32_dpp v21, v48, v9 row_newbcast:15 row_mask:0xf bank_mask:0xf
  v_and_b32_dpp v22, v48, v10 row_newbcast:15 row_mask:0xf bank_mask:0xf
  v_and_b32_dpp v23, v48, v11 row_newbcast:15 row_mask:0xf bank_mask:0xf
  v_mfma_f32_16x16x32_bf16 v[12:15], v[16:19], a[120:123], v[12:15]
  v_and_b32_dpp v16, v49, v8 row_newbcast:0 row_mask:0xf bank_mask:0xf
  v_and_b32_dpp v17, v49, v9 row_newbcast:0 row_mask:0xf bank_mask:0xf
  v_and_b32_dpp v18, v49, v10 row_newbcast:0 row_mask:0xf bank_mask:0xf
  v_and_b32_dpp v19, v49, v11 row_newbcast:0 row_mask:0xf bank_mask:0xf
  v_mfma_f32_16x16x32_bf16 v[12:15], v[20:23], a[124:127], v[12:15]
  v_and_b32_dpp v20, v49, v8 row_newbcast:1 row_mask:0xf bank_mask:0xf
  v_and_b32_dpp v21, v49, v9 row_newbcast:1 row_mask:0xf bank_mask:0xf
  v_and_b32_dpp v22, v49, v10 row_newbcast:1 row_mask:0xf bank_mask:0xf
  v_and_b32_dpp v23, v49, v11 row_newbcast:1 row_mask:0xf bank_mask:0xf
  v_mfma_f32_16x16x32_bf16 v[12:15], v[16:19], a[128:131], v[12:15]
  v_and_b32_dpp v16, v49, v8 row_newbcast:2 row_mask:0xf bank_mask:0xf
  v_and_b32_dpp v17, v49, v9 row_newbcast:2 row_mask:0xf bank_mask:0xf
  v_and_b32_dpp v18, v49, v10 row_newbcast:2 row_mask:0xf bank_mask:0xf
  v_and_b32_dpp v19, v49, v11 row_newbcast:2 row_mask:0xf bank_mask:0xf
  v_mfma_f32_16x16x32_bf16 v[12:15], v[20:23], a[132:135], v[12:15]
  v_and_b32_dpp v20, v49, v8 row_newbcast:3 row_mask:0xf bank_mask:0xf
  v_and_b32_dpp v21, v49, v9 row_newbcast:3 row_mask:0xf bank_mask:0xf
  v_and_b32_dpp v22, v49, v10 row_newbcast:3 row_mask:0xf bank_mask:0xf
  v_and_b32_dpp v23, v49, v11 row_newbcast:3 row_mask:0xf bank_mask:0xf
  v_mfma_f32_16x16x32_bf16 v[12:15], v[16:19], a[136:139], v[12:15]
  v_and_b32_dpp v16, v49, v8 row_newbcast:4 row_mask:0xf bank_mask:0xf
  v_and_b32_dpp v17, v49, v9 row_newbcast:4 row_mask:0xf bank_mask:0xf
  v_and_b32_dpp v18, v49, v10 row_newbcast:4 row_mask:0xf bank_mask:0xf
  v_and_b32_dpp v19, v49, v11 row_newbcast:4 row_mask:0xf bank_mask:0xf
  v_mfma_f32_16x16x32_bf16 v[12:15], v[20:23], a[140:143], v[12:15]
  v_and_b32_dpp v20, v49, v8 row_newbcast:5 row_mask:0xf bank_mask:0xf
  v_and_b32_dpp v21, v49, v9 row_newbcast:5 row_mask:0xf bank_mask:0xf
  v_and_b32_dpp v22, v49, v10 row_newbcast:5 row_mask:0xf bank_mask:0xf
  v_and_b32_dpp v23, v49, v11 row_newbcast:5 row_mask:0xf bank_mask:0xf
  v_mfma_f32_16x16x32_bf16 v[12:15], v[16:19], a[144:147], v[12:15]
  v_and_b32_dpp v16, v49, v8 row_newbcast:6 row_mask:0xf bank_mask:0xf
  v_and_b32_dpp v17, v49, v9 row_newbcast:6 row_mask:0xf bank_mask:0xf
  v_and_b32_dpp v18, v49, v10 row_newbcast:6 row_mask:0xf bank_mask:0xf
  v_and_b32_dpp v19, v49, v11 row_newbcast:6 row_mask:0xf bank_mask:0xf
  v_mfma_f32_16x16x32_bf16 v[12:15], v[20:23], a[148:151], v[12:15]
  v_and_b32_dpp v20, v49, v8 row_newbcast:7 row_mask:0xf bank_mask:0xf
  v_and_b32_dpp v21, v49, v9 row_newbcast:7 row_mask:0xf bank_mask:0xf
  v_and_b32_dpp v22, v49, v10 row_newbcast:7 row_mask:0xf bank_mask:0xf
  v_and_b32_dpp v23, v49, v11 row_newbcast:7 row_mask:0xf bank_mask:0xf
  v_mfma_f32_16x16x32_bf16 v[12:15], v[16:19], a[152:155], v[12:15]
  v_and_b32_dpp v16, v49, v8 row_newbcast:8 row_mask:0xf bank_mask:0xf
  v_and_b32_dpp v17, v49, v9 row_newbcast:8 row_mask:0xf bank_mask:0xf
  v_and_b32_dpp v18, v49, v10 row_newbcast:8 row_mask:0xf bank_mask:0xf
  v_and_b32_dpp v19, v49, v11 row_newbcast:8 row_mask:0xf bank_mask:0xf
  v_mfma_f32_16x16x32_bf16 v[12:15], v[20:23], a[156:159], v[12:15]
  v_and_b32_dpp v20, v49, v8 row_newbcast:9 row_mask:0xf bank_mask:0xf
  v_and_b32_dpp v21, v49, v9 row_newbcast:9 row_mask:0xf bank_mask:0xf
  v_and_b32_dpp v22, v49, v10 row_newbcast:9 row_mask:0xf bank_mask:0xf
  v_and_b32_dpp v23, v49, v11 row_newbcast:9 row_mask:0xf bank_mask:0xf
  v_mfma_f32_16x16x32_bf16 v[12:15], v[16:19], a[160:163], v[12:15]
  v_and_b32_dpp v16, v49, v8 row_newbcast:10 row_mask:0xf bank_mask:0xf
  v_and_b32_dpp v17, v49, v9 row_newbcast:10 row_mask:0xf bank_mask:0xf
  v_and_b32_dpp v18, v49, v10 row_newbcast:10 row_mask:0xf bank_mask:0xf
  v_and_b32_dpp v19, v49, v11 row_newbcast:10 row_mask:0xf bank_mask:0xf
  v_mfma_f32_16x16x32_bf16 v[12:15], v[20:23], a[164:167], v[12:15]
  v_and_b32_dpp v20, v49, v8 row_newbcast:11 row_mask:0xf bank_mask:0xf
  v_and_b32_dpp v21, v49, v9 row_newbcast:11 row_mask:0xf bank_mask:0xf
  v_and_b32_dpp v22, v49, v10 row_newbcast:11 row_mask:0xf bank_mask:0xf
  v_and_b32_dpp v23, v49, v11 row_newbcast:11 row_mask:0xf bank_mask:0xf
  v_mfma_f32_16x16x32_bf16 v[12:15], v[16:19], a[168:171], v[12:15]
  v_and_b32_dpp v16, v49, v8 row_newbcast:12 row_mask:0xf bank_mask:0xf
  v_and_b32_dpp v17, v49, v9 row_newbcast:12 row_mask:0xf bank_mask:0xf
  v_and_b32_dpp v18, v49, v10 row_newbcast:12 row_mask:0xf bank_mask:0xf
  v_and_b32_dpp v19, v49, v11 row_newbcast:12 row_mask:0xf bank_mask:0xf
  v_mfma_f32_16x16x32_bf16 v[12:15], v[20:23], a[172:175], v[12:15]
  v_and_b32_dpp v20, v49, v8 row_newbcast:13 row_mask:0xf bank_mask:0xf
  v_and_b32_dpp v21, v49, v9 row_newbcast:13 row_mask:0xf bank_mask:0xf
  v_and_b32_dpp v22, v49, v10 row_newbcast:13 row_mask:0xf bank_mask:0xf
  v_and_b32_dpp v23, v49, v11 row_newbcast:13 row_mask:0xf bank_mask:0xf
  v_mfma_f32_16x16x32_bf16 v[12:15], v[16:19], a[176:179], v[12:15]
  v_and_b32_dpp v16, v49, v8 row_newbcast:14 row_mask:0xf bank_mask:0xf
  v_and_b32_dpp v17, v49, v9 row_newbcast:14 row_mask:0xf bank_mask:0xf
  v_and_b32_dpp v18, v49, v10 row_newbcast:14 row_mask:0xf bank_mask:0xf
  v_and_b32_dpp v19, v49, v11 row_newbcast:14 row_mask:0xf bank_mask:0xf
  v_mfma_f32_16x16x32_bf16 v[12:15], v[20:23], a[180:183], v[12:15]
  v_and_b32_dpp v20, v49, v8 row_newbcast:15 row_mask:0xf bank_mask:0xf
  v_and_b32_dpp v21, v49, v9 row_newbcast:15 row_mask:0xf bank_mask:0xf
  v_and_b32_dpp v22, v49, v10 row_newbcast:15 row_mask:0xf bank_mask:0xf
  v_and_b32_dpp v23, v49, v11 row_newbcast:15 row_mask:0xf bank_mask:0xf
  v_mfma_f32_16x16x32_bf16 v[12:15], v[16:19], a[184:187], v[12:15]
  s_nop 1
  v_mfma_f32_16x16x32_bf16 v[12:15], v[20:23], a[188:191], v[12:15]
  s_nop 7
  v_mov_b32 v53, 0xfffffc00
  v_add_u32 v12, 0x200, v12
  v_add_u32 v13, 0x200, v13
  v_add_u32 v14, 0x200, v14
  v_add_u32 v15, 0x200, v15
  v_and_or_b32 v12, v12, v53, s18
  v_and_or_b32 v13, v13, v53, s19
  v_and_or_b32 v14, v14, v53, s20
  v_and_or_b32 v15, v15, v53, s21
  s_mov_b32 exec_lo, 0xffffffff
  s_mov_b32 exec_hi, 0x0
  buffer_store_dwordx4 v[12:15], v50, s[60:63], 0 offen sc1
  s_mov_b64 exec, -1
L_roles:
  s_cmp_eq_u32 s84, 1
  s_cbranch_scc1 L_red
  s_cmp_eq_u32 s84, 2
  s_cbranch_scc0 L_fin
  s_lshl_b32 s10, s85, 7
  s_lshl_b32 s11, s3, 5
  s_add_u32 s10, s10, s11
  v_and_b32 v44, 15, v2
  v_lshlrev_b32 v44, 1, v44
  v_add_u32 v44, s10, v44
  s_lshl_b32 s10, s3, 14
  s_add_u32 m0, s10, 12288
  s_mov_b32 s11, 344064
  buffer_load_dwordx4 v197, s[64:67], s11 offen nt lds
  s_lshl_b32 s10, s3, 14
  s_add_u32 m0, s10, 13312
  s_mov_b32 s11, 372736
  buffer_load_dwordx4 v198, s[64:67], s11 offen nt lds
  s_lshl_b32 s10, s3, 14
  s_add_u32 m0, s10, 14336
  s_mov_b32 s11, 401408
  buffer_load_dwordx4 v197, s[64:67], s11 offen nt lds
  s_lshl_b32 s10, s3, 14
  s_add_u32 m0, s10, 15360
  s_mov_b32 s11, 430080
  buffer_load_dwordx4 v198, s[64:67], s11 offen nt lds
  buffer_load_ushort v221, v44, s[96:99], 0 offen
  s_mov_b32 s82, 0
  buffer_load_dwordx4 a[192:195], v199, s[92:95], s82 offen nt
  buffer_load_dwordx4 a[196:199], v199, s[92:95], s82 offen offset:1024 nt
  buffer_load_dwordx4 a[200:203], v199, s[92:95], s82 offen offset:2048 nt
  s_branch L_over_5
L_stub_5:
  s_branch L_back_1
L_over_5:
  buffer_load_dwordx4 a[204:207], v199, s[92:95], s82 offen offset:3072 nt
  s_mov_b32 s82, 4096
  buffer_load_dwordx4 a[208:211], v199, s[92:95], s82 offen nt
  buffer_load_dwordx4 a[212:215], v199, s[92:95], s82 offen offset:1024 nt
  buffer_load_dwordx4 a[216:219], v199, s[92:95], s82 offen offset:2048 nt
  buffer_load_dwordx4 a[220:223], v199, s[92:95], s82 offen offset:3072 nt
  s_mov_b32 s82, 8192
  buffer_load_dwordx4 a[224:227], v199, s[92:95], s82 offen nt
  buffer_load_dwordx4 a[228:231], v199, s[92:95], s82 offen offset:1024 nt
  buffer_load_dwordx4 a[232:235], v199, s[92:95], s82 offen offset:2048 nt
  buffer_load_dwordx4 a[236:239], v199, s[92:95], s82 offen offset:3072 nt
  s_mov_b32 s82, 12288
  buffer_load_dwordx4 a[240:243], v199, s[92:95], s82 offen nt
  buffer_load_dwordx4 a[244:247], v199, s[92:95], s82 offen offset:1024 nt
  buffer_load_dwordx4 a[248:251], v199, s[92:95], s82 offen offset:2048 nt
  buffer_load_dwordx4 a[252:255], v199, s[92:95], s82 offen offset:3072 nt
  v_and_b32 v45, 15, v2
  v_cmp_eq_u32 vcc, 2, v45
  v_mov_b32 v46, 0x3f803f80
  s_nop 0
  v_cndmask_b32 v46, 0, v46, vcc
  v_mov_b32 v128, v46
  v_mov_b32 v129, v46
  v_mov_b32 v130, v46
  v_mov_b32 v131, v46
  v_mov_b32 v132, v46
  v_mov_b32 v133, v46
  v_mov_b32 v134, v46
  v_mov_b32 v135, v46
  v_mov_b32 v136, v46
  v_mov_b32 v137, v46
  v_mov_b32 v138, v46
  v_mov_b32 v139, v46
  v_mov_b32 v140, v46
  v_mov_b32 v141, v46
  v_mov_b32 v142, v46
  v_mov_b32 v143, v46
  v_mov_b32 v144, v46
  v_mov_b32 v145, v46
  v_mov_b32 v146, v46
  v_mov_b32 v147, v46
  v_mov_b32 v148, v46
  v_mov_b32 v149, v46
  v_mov_b32 v150, v46
  v_mov_b32 v151, v46
  v_mov_b32 v152, v46
  v_mov_b32 v153, v46
  v_mov_b32 v154, v46
  v_mov_b32 v155, v46
  v_mov_b32 v156, v46
  v_mov_b32 v157, v46
  v_mov_b32 v158, v46
  v_mov_b32 v159, v46
  v_mov_b32 v160, v46
  v_mov_b32 v161, v46
  v_mov_b32 v162, v46
  v_mov_b32 v163, v46
  v_mov_b32 v164, v46
  v_mov_b32 v165, v46
  v_mov_b32 v166, v46
  v_mov_b32 v167, v46
  v_mov_b32 v168, v46
  v_mov_b32 v169, v46
  v_mov_b32 v170, v46
  v_mov_b32 v171, v46
  v_mov_b32 v172, v46
  v_mov_b32 v173, v46
  v_mov_b32 v174, v46
  v_mov_b32 v175, v46
  v_mov_b32 v176, v46
  v_mov_b32 v177, v46
  v_mov_b32 v178, v46
  v_mov_b32 v179, v46
  v_mov_b32 v180, v46
  v_mov_b32 v181, v46
  v_mov_b32 v182, v46
  v_mov_b32 v183, v46
  v_mov_b32 v184, v46
  v_mov_b32 v185, v46
  v_mov_b32 v186, v46
  v_mov_b32 v187, v46
  v_mov_b32 v188, v46
  v_mov_b32 v189, v46
  v_mov_b32 v190, v46
  v_mov_b32 v191, v46
  v_lshrrev_b32 v42, 4, v2
  v_bfe_u32 v43, v2, 2, 2
  v_lshlrev_b32 v47, 10, v42
  v_lshl_or_b32 v47, v43, 7, v47
  v_lshrrev_b32 v43, 1, v43
  v_and_b32 v42, 1, v42
  v_lshl_or_b32 v43, v42, 1, v43
  v_xor_b32 v43, s3, v43
  v_lshl_or_b32 v47, v43, 5, v47
  v_and_b32 v43, 3, v2
  v_lshl_or_b32 v47, v43, 3, v47
  s_waitcnt vmcnt(17)
  s_barrier
  ds_read_b64_tr_b16 v[64:65], v47 offset:0
  ds_read_b64_tr_b16 v[66:67], v47 offset:512
  ds_read_b64_tr_b16 v[68:69], v47 offset:4096
  ds_read_b64_tr_b16 v[70:71], v47 offset:4608
  ds_read_b64_tr_b16 v[72:73], v47 offset:8192
  ds_read_b64_tr_b16 v[74:75], v47 offset:8704
  ds_read_b64_tr_b16 v[76:77], v47 offset:12288
  ds_read_b64_tr_b16 v[78:79], v47 offset:12800
  s_waitcnt lgkmcnt(0)
  ds_read_b64_tr_b16 v[80:81], v47 offset:16384
  ds_read_b64_tr_b16 v[82:83], v47 offset:16896
  ds_read_b64_tr_b16 v[84:85], v47 offset:20480
  ds_read_b64_tr_b16 v[86:87], v47 offset:20992
  ds_read_b64_tr_b16 v[88:89], v47 offset:24576
  ds_read_b64_tr_b16 v[90:91], v47 offset:25088
  ds_read_b64_tr_b16 v[92:93], v47 offset:28672
  ds_read_b64_tr_b16 v[94:95], v47 offset:29184
  s_waitcnt lgkmcnt(0)
  ds_read_b64_tr_b16 v[96:97], v47 offset:32768
  ds_read_b64_tr_b16 v[98:99], v47 offset:33280
  ds_read_b64_tr_b16 v[100:101], v47 offset:36864
  ds_read_b64_tr_b16 v[102:103], v47 offset:37376
  ds_read_b64_tr_b16 v[104:105], v47 offset:40960
  ds_read_b64_tr_b16 v[106:107], v47 offset:41472
  ds_read_b64_tr_b16 v[108:109], v47 offset:45056
  ds_read_b64_tr_b16 v[110:111], v47 offset:45568
  s_waitcnt lgkmcnt(0)
  ds_read_b64_tr_b16 v[112:113], v47 offset:49152
  ds_read_b64_tr_b16 v[114:115], v47 offset:49664
  ds_read_b64_tr_b16 v[116:117], v47 offset:53248
  ds_read_b64_tr_b16 v[118:119], v47 offset:53760
  ds_read_b64_tr_b16 v[120:121], v47 offset:57344
  ds_read_b64_tr_b16 v[122:123], v47 offset:57856
  ds_read_b64_tr_b16 v[124:125], v47 offset:61440
  ds_read_b64_tr_b16 v[126:127], v47 offset:61952
  s_waitcnt lgkmcnt(0)
  v_lshlrev_b32 v44, 6, v2
  v_add_u32 v44, 659456, v44
  s_lshl_b32 s10, s3, 11
  s_add_u32 s10, s10, 65536
  v_lshlrev_b32 v50, 5, v2
  v_add_u32 v50, s10, v50
  v_and_b32 v51, 15, v2
  v_lshlrev_b32 v51, 10, v51
  v_lshrrev_b32 v46, 4, v2
  v_lshl_or_b32 v51, v46, 4, v51
  v_add_u32 v51, s10, v51
  s_lshl_b32 s11, s3, 11
  v_subrev_u32 v51, s11, v51
  s_lshl_b32 s11, s3, 10
  s_add_u32 s11, s11, 659456
  s_bfe_u32 s13, s85, 0x10002
  s_lshl_b32 s13, s13, 13
  s_add_u32 s11, s11, s13
  v_add_u32 v44, s11, v1
  s_lshl_b32 s11, s3, 9
  s_add_u32 s11, s11, 65536
  v_lshrrev_b32 v50, 5, v2
  v_lshlrev_b32 v50, 8, v50
  v_and_b32 v56, 15, v2
  v_lshl_or_b32 v50, v56, 4, v50
  v_bfe_u32 v56, v2, 4, 1
  v_lshl_or_b32 v50, v56, 3, v50
  v_add_u32 v50, s11, v50
  s_lshl_b32 s11, s3, 3
  s_add_u32 s11, s11, 77824
  v_mov_b32 v56, s11
  v_lshrrev_b32 v57, 5, v2
  v_lshlrev_b32 v57, 4, v57
  v_add_u32 v57, 77824, v57
  v_and_b32 v52, 15, v2
  v_lshlrev_b32 v52, 2, v52
  s_lshl_b32 s11, s3, 6
  s_add_u32 s11, s11, 77888
  v_add_u32 v52, s11, v52
  v_bfe_u32 v53, v2, 3, 1
  v_lshlrev_b32 v53, 8, v53
  v_lshl_or_b32 v53, v46, 6, v53
  v_add_u32 v53, 77888, v53
  v_and_b32 v54, 15, v2
  v_lshlrev_b32 v54, 4, v54
  v_and_b32 v55, 1, v46
  v_lshl_or_b32 v54, v55, 13, v54
  v_lshrrev_b32 v55, 1, v46
  v_lshl_or_b32 v54, v55, 10, v54
  s_lshr_b32 s10, s85, 2
  s_lshl_b32 s10, s10, 14
  s_and_b32 s11, s85, 3
  s_lshl_b32 s11, s11, 11
  s_add_u32 s10, s10, s11
  s_lshl_b32 s11, s3, 8
  s_add_u32 s10, s10, s11
  s_add_u32 s10, s10, 524288
  v_add_u32 v54, s10, v54
  s_waitcnt vmcnt(0)
  v_lshlrev_b32 v221, 16, v221
  s_mov_b32 s10, 0x07060302
  s_mov_b32 s83, 20000
  buffer_load_dwordx4 v[240:243], v44, s[60:63], 0 offen sc1
L_pp_h_7:
  s_waitcnt vmcnt(0)
  v_xor_b32 v24, s22, v240
  v_xor_b32 v25, s22, v241
  v_xor_b32 v26, s22, v242
  v_xor_b32 v27, s22, v243
  v_or3_b32 v45, v24, v25, v26
  v_or_b32 v45, v45, v27
  v_and_b32 v45, 0xffff, v45
  v_cmp_ne_u32 vcc, 0, v45
  s_sub_u32 s83, s83, 1
  s_cbranch_scc1 L_ppx_h_8
  s_nop 0
  s_cbranch_vccz L_ppx_h_8
  s_and_b64 exec, exec, vcc
  buffer_load_dwordx4 v[240:243], v44, s[60:63], 0 offen sc1
  s_branch L_pp_h_7
L_ppx_h_8:
  s_mov_b64 exec, -1
  v_perm_b32 v16, v25, v24, s10
  v_perm_b32 v17, v27, v26, s10
  ds_write_b64 v50, v[16:17]
  v_add_f32 v28, v24, v25
  v_add_f32 v29, v26, v27
  v_add_f32 v28, v28, v29
  s_nop 1
  v_add_f32_dpp v28, v28, v28 row_ror:8 row_mask:0xf bank_mask:0xf
  s_nop 1
  v_add_f32_dpp v28, v28, v28 row_ror:4 row_mask:0xf bank_mask:0xf
  s_nop 1
  v_add_f32_dpp v28, v28, v28 row_ror:2 row_mask:0xf bank_mask:0xf
  s_nop 1
  v_add_f32_dpp v28, v28, v28 row_ror:1 row_mask:0xf bank_mask:0xf
  v_mov_b32 v42, v28
  s_nop 1
  v_permlane16_swap_b32 v28, v42
  s_nop 0
  v_add_f32 v28, v28, v42
  v_mov_b32 v42, v28
  s_nop 1
  v_permlane32_swap_b32 v28, v42
  s_nop 0
  v_add_f32 v28, v28, v42
  v_mul_f32 v42, 0x3b800000, v28
  v_sub_f32 v24, v24, v42
  v_sub_f32 v25, v25, v42
  v_sub_f32 v26, v26, v42
  v_sub_f32 v27, v27, v42
  v_mul_f32 v29, v24, v24
  v_fma_f32 v29, v25, v25, v29
  v_fma_f32 v29, v26, v26, v29
  v_fma_f32 v29, v27, v27, v29
  s_nop 1
  v_add_f32_dpp v29, v29, v29 row_ror:8 row_mask:0xf bank_mask:0xf
  s_nop 1
  v_add_f32_dpp v29, v29, v29 row_ror:4 row_mask:0xf bank_mask:0xf
  s_nop 1
  v_add_f32_dpp v29, v29, v29 row_ror:2 row_mask:0xf bank_mask:0xf
  s_nop 1
  v_add_f32_dpp v29, v29, v29 row_ror:1 row_mask:0xf bank_mask:0xf
  v_mov_b32 v42, v29
  s_nop 1
  v_permlane16_swap_b32 v29, v42
  s_nop 0
  v_add_f32 v29, v29, v42
  v_mov_b32 v42, v29
  s_nop 1
  v_permlane32_swap_b32 v29, v42
  s_nop 0
  v_add_f32 v29, v29, v42
  s_mov_b32 exec_lo, 0x1
  s_mov_b32 exec_hi, 0x0
  ds_write_b64 v56, v[28:29]
  s_mov_b64 exec, -1
  s_waitcnt lgkmcnt(0)
  s_barrier
  ds_read_b128 v[32:35], v57
  s_mov_b32 exec_lo, 0x30003
  s_mov_b32 exec_hi, 0x30003
  ds_read_b128 v[128:131], v51 offset:0
  ds_read_b128 v[132:135], v51 offset:64
  ds_read_b128 v[136:139], v51 offset:128
  ds_read_b128 v[140:143], v51 offset:192
  ds_read_b128 v[144:147], v51 offset:256
  ds_read_b128 v[148:151], v51 offset:320
  ds_read_b128 v[152:155], v51 offset:384
  ds_read_b128 v[156:159], v51 offset:448
  ds_read_b128 v[160:163], v51 offset:512
  ds_read_b128 v[164:167], v51 offset:576
  ds_read_b128 v[168:171], v51 offset:640
  ds_read_b128 v[172:175], v51 offset:704
  ds_read_b128 v[176:179], v51 offset:768
  ds_read_b128 v[180:183], v51 offset:832
  ds_read_b128 v[184:187], v51 offset:896
  s_waitcnt lgkmcnt(15)
  ds_read_b128 v[188:191], v51 offset:960
  s_mov_b64 exec, -1
  v_add_f32 v42, v32, v34
  v_sub_f32 v44, v32, v34
  v_add_f32 v43, v33, v35
  v_mul_f32 v44, v44, v44
  v_mul_f32 v42, 0x3b000000, v42
  s_waitcnt lgkmcnt(15)
  v_mfma_f32_16x16x32_bf16 v[12:15], v[128:131], v[64:67], 0
  v_mul_f32 v44, 0x3b000000, v44
  s_waitcnt lgkmcnt(14)
  v_mfma_f32_16x16x32_bf16 v[12:15], v[132:135], v[68:71], v[12:15]
  v_add_f32 v43, v43, v44
  s_waitcnt lgkmcnt(13)
  v_mfma_f32_16x16x32_bf16 v[12:15], v[136:139], v[72:75], v[12:15]
  v_mul_f32 v43, 0x3b000000, v43
  s_waitcnt lgkmcnt(12)
  v_mfma_f32_16x16x32_bf16 v[12:15], v[140:143], v[76:79], v[12:15]
  v_cvt_pk_bf16_f32 v42, v42, v42
  s_waitcnt lgkmcnt(11)
  v_mfma_f32_16x16x32_bf16 v[12:15], v[144:147], v[80:83], v[12:15]
  v_and_b32 v42, 0xffff0000, v42
  s_waitcnt lgkmcnt(10)
  v_mfma_f32_16x16x32_bf16 v[12:15], v[148:151], v[84:87], v[12:15]
  v_cvt_pk_bf16_f32 v43, v43, v43
  s_waitcnt lgkmcnt(9)
  v_mfma_f32_16x16x32_bf16 v[12:15], v[152:155], v[88:91], v[12:15]
  v_and_b32 v43, 0xffff0000, v43
  s_waitcnt lgkmcnt(8)
  v_mfma_f32_16x16x32_bf16 v[12:15], v[156:159], v[92:95], v[12:15]
  v_add_f32 v43, 0x3727c5ac, v43
  s_waitcnt lgkmcnt(7)
  v_mfma_f32_16x16x32_bf16 v[12:15], v[160:163], v[96:99], v[12:15]
  v_cvt_pk_bf16_f32 v43, v43, v43
  s_waitcnt lgkmcnt(6)
  v_mfma_f32_16x16x32_bf16 v[12:15], v[164:167], v[100:103], v[12:15]
  v_and_b32 v43, 0xffff0000, v43
  s_waitcnt lgkmcnt(5)
  v_mfma_f32_16x16x32_bf16 v[12:15], v[168:171], v[104:107], v[12:15]
  v_sqrt_f32 v43, v43
  s_waitcnt lgkmcnt(4)
  v_mfma_f32_16x16x32_bf16 v[12:15], v[172:175], v[108:111], v[12:15]
  s_nop 0
  s_waitcnt lgkmcnt(3)
  v_mfma_f32_16x16x32_bf16 v[12:15], v[176:179], v[112:115], v[12:15]
  v_cvt_pk_bf16_f32 v43, v43, v43
  s_waitcnt lgkmcnt(2)
  v_mfma_f32_16x16x32_bf16 v[12:15], v[180:183], v[116:119], v[12:15]
  v_and_b32 v43, 0xffff0000, v43
  s_waitcnt lgkmcnt(1)
  v_mfma_f32_16x16x32_bf16 v[12:15], v[184:187], v[120:123], v[12:15]
  v_rcp_f32 v43, v43
  s_waitcnt lgkmcnt(0)
  v_mfma_f32_16x16x32_bf16 v[12:15], v[188:191], v[124:127], v[12:15]
  s_nop 0
  s_nop 0
  v_readlane_b32 s10, v42, 0
  v_readlane_b32 s11, v43, 0
  v_readlane_b32 s12, v42, 32
  v_readlane_b32 s13, v43, 32
  s_nop 7
  v_fma_f32 v12, -s10, v14, v12
  v_mul_f32 v12, s11, v12
  v_fma_f32 v13, -s12, v14, v13
  v_mul_f32 v13, s13, v13
  v_cvt_pk_bf16_f32 v12, v12, v12
  v_and_b32 v12, 0xffff0000, v12
  v_add_f32 v12, v12, v221
  v_cvt_pk_bf16_f32 v12, v12, v12
  v_and_b32 v12, 0xffff0000, v12
  v_cvt_pk_bf16_f32 v13, v13, v13
  v_and_b32 v13, 0xffff0000, v13
  v_add_f32 v13, v13, v221
  v_cvt_pk_bf16_f32 v13, v13, v13
  v_and_b32 v13, 0xffff0000, v13
  v_mul_f32 v45, v12, v12
  v_mul_f32 v45, 0x3d372713, v45
  v_fma_f32 v45, v45, v12, v12
  v_mul_f32 v45, 0xc0135761, v45
  v_exp_f32 v45, v45
  s_nop 0
  v_add_f32 v45, 1.0, v45
  v_rcp_f32 v45, v45
  s_nop 0
  v_mul_f32 v12, v12, v45
  v_mul_f32 v46, v13, v13
  v_mul_f32 v46, 0x3d372713, v46
  v_fma_f32 v46, v46, v13, v13
  v_mul_f32 v46, 0xc0135761, v46
  v_exp_f32 v46, v46
  s_nop 0
  v_add_f32 v46, 1.0, v46
  v_rcp_f32 v46, v46
  s_nop 0
  v_mul_f32 v13, v13, v46
  v_cvt_pk_bf16_f32 v12, v12, v12
  v_cvt_pk_bf16_f32 v13, v13, v13
  s_mov_b32 exec_lo, 0xffff
  s_mov_b32 exec_hi, 0x0
  ds_write_b32 v52, v12
  ds_write_b32 v52, v13 offset:256
  s_mov_b64 exec, -1
  s_waitcnt lgkmcnt(0)
  s_barrier
  ds_read_b128 v[224:227], v53 offset:0
  ds_read_b128 v[228:231], v53 offset:16
  ds_read_b128 v[232:235], v53 offset:32
  ds_read_b128 v[236:239], v53 offset:48
  s_waitcnt lgkmcnt(3)
  v_and_b32 v16, v224, v192
  v_and_b32 v17, v224, v193
  v_and_b32 v18, v224, v194
  v_and_b32 v19, v224, v195
  v_and_b32 v20, v225, v192
  v_and_b32 v21, v225, v193
  v_and_b32 v22, v225, v194
  v_and_b32 v23, v225, v195
  v_mfma_f32_16x16x32_bf16 v[12:15], v[16:19], a[192:195], 0
  v_and_b32 v16, v226, v192
  v_and_b32 v17, v226, v193
  v_and_b32 v18, v226, v194
  v_and_b32 v19, v226, v195
  v_mfma_f32_16x16x32_bf16 v[12:15], v[20:23], a[196:199], v[12:15]
  v_and_b32 v20, v227, v192
  v_and_b32 v21, v227, v193
  v_and_b32 v22, v227, v194
  v_and_b32 v23, v227, v195
  v_mfma_f32_16x16x32_bf16 v[12:15], v[16:19], a[200:203], v[12:15]
  s_waitcnt lgkmcnt(2)
  v_and_b32 v16, v228, v192
  v_and_b32 v17, v228, v193
  v_and_b32 v18, v228, v194
  v_and_b32 v19, v228, v195
  v_mfma_f32_16x16x32_bf16 v[12:15], v[20:23], a[204:207], v[12:15]
  v_and_b32 v20, v229, v192
  v_and_b32 v21, v229, v193
  v_and_b32 v22, v229, v194
  v_and_b32 v23, v229, v195
  v_mfma_f32_16x16x32_bf16 v[12:15], v[16:19], a[208:211], v[12:15]
  v_and_b32 v16, v230, v192
  v_and_b32 v17, v230, v193
  v_and_b32 v18, v230, v194
  v_and_b32 v19, v230, v195
  v_mfma_f32_16x16x32_bf16 v[12:15], v[20:23], a[212:215], v[12:15]
  v_and_b32 v20, v231, v192
  v_and_b32 v21, v231, v193
  v_and_b32 v22, v231, v194
  v_and_b32 v23, v231, v195
  v_mfma_f32_16x16x32_bf16 v[12:15], v[16:19], a[216:219], v[12:15]
  s_waitcnt lgkmcnt(1)
  v_and_b32 v16, v232, v192
  v_and_b32 v17, v232, v193
  v_and_b32 v18, v232, v194
  v_and_b32 v19, v232, v195
  v_mfma_f32_16x16x32_bf16 v[12:15], v[20:23], a[220:223], v[12:15]
  v_and_b32 v20, v233, v192
  v_and_b32 v21, v233, v193
  v_and_b32 v22, v233, v194
  v_and_b32 v23, v233, v195
  v_mfma_f32_16x16x32_bf16 v[12:15], v[16:19], a[224:227], v[12:15]
  v_and_b32 v16, v234, v192
  v_and_b32 v17, v234, v193
  v_and_b32 v18, v234, v194
  v_and_b32 v19, v234, v195
  v_mfma_f32_16x16x32_bf16 v[12:15], v[20:23], a[228:231], v[12:15]
  v_and_b32 v20, v235, v192
  v_and_b32 v21, v235, v193
  v_and_b32 v22, v235, v194
  v_and_b32 v23, v235, v195
  v_mfma_f32_16x16x32_bf16 v[12:15], v[16:19], a[232:235], v[12:15]
  s_waitcnt lgkmcnt(0)
  v_and_b32 v16, v236, v192
  v_and_b32 v17, v236, v193
  v_and_b32 v18, v236, v194
  v_and_b32 v19, v236, v195
  v_mfma_f32_16x16x32_bf16 v[12:15], v[20:23], a[236:239], v[12:15]
  v_and_b32 v20, v237, v192
  v_and_b32 v21, v237, v193
  v_and_b32 v22, v237, v194
  v_and_b32 v23, v237, v195
  v_mfma_f32_16x16x32_bf16 v[12:15], v[16:19], a[240:243], v[12:15]
  v_and_b32 v16, v238, v192
  v_and_b32 v17, v238, v193
  v_and_b32 v18, v238, v194
  v_and_b32 v19, v238, v195
  v_mfma_f32_16x16x32_bf16 v[12:15], v[20:23], a[244:247], v[12:15]
  v_and_b32 v20, v239, v192
  v_and_b32 v21, v239, v193
  v_and_b32 v22, v239, v194
  v_and_b32 v23, v239, v195
  v_mfma_f32_16x16x32_bf16 v[12:15], v[16:19], a[248:251], v[12:15]
  s_nop 1
  v_mfma_f32_16x16x32_bf16 v[12:15], v[20:23], a[252:255], v[12:15]
  s_nop 7
  v_mov_b32 v55, 0xfffffc00
  v_add_u32 v12, 0x200, v12
  v_add_u32 v13, 0x200, v13
  v_add_u32 v14, 0x200, v14
  v_add_u32 v15, 0x200, v15
  v_and_or_b32 v12, v12, v55, s18
  v_and_or_b32 v13, v13, v55, s19
  v_and_or_b32 v14, v14, v55, s20
  v_and_or_b32 v15, v15, v55, s21
  buffer_store_dwordx4 v[12:15], v54, s[60:63], 0 offen sc1
  s_branch L_fin
L_red:
  s_cmp_eq_u32 s3, 1
  s_cselect_b64 s[86:87], -1, 0
  v_and_b32 v46, 3, v2
  v_lshrrev_b32 v47, 4, v2
  v_bfe_u32 v48, v2, 2, 2
  v_lshl_or_b32 v53, v46, 2, v47
  v_cndmask_b32_e64 v47, v47, v46, s[86:87]
  v_cndmask_b32_e64 v46, v46, v48, s[86:87]
  s_and_b32 s12, s85, 31
  s_lshr_b32 s10, s12, 3
  s_lshl_b32 s10, s10, 7
  s_bfe_u32 s11, s12, 0x10002
  s_lshl_b32 s11, s11, 2
  s_add_u32 s10, s10, s11
  s_and_b32 s11, s12, 3
  s_lshl_b32 s11, s11, 5
  s_add_u32 s10, s10, s11
  v_lshl_or_b32 v54, v46, 3, v47
  v_add_u32 v54, s10, v54
  v_lshlrev_b32 v54, 1, v54
  s_lshr_b32 s13, s85, 5
  s_lshl_b32 s10, s13, 10
  v_add_u32 v55, s10, v54
  s_mov_b32 s68, s16
  s_mov_b32 s69, s17
  s_mov_b32 s70, 2048
  s_mov_b32 s71, 0x00020000
  buffer_load_ushort v222, v55, s[68:71], 0 offen
  buffer_load_ushort v221, v54, s[96:99], 0 offen
  s_lshl_b32 s10, s3, 2
  s_add_u32 s10, s10, 73728
  v_lshl_add_u32 v53, v53, 4, s10
  v_lshl_or_b32 v52, v46, 2, v47
  v_lshlrev_b32 v52, 4, v52
  v_add_u32 v52, 73728, v52
  s_bfe_u32 s27, s85, 0x10002
  s_and_b32 s10, s85, 0x3a
  s_or_b32 s10, s10, s27
  s_and_b32 s11, s85, 1
  s_lshl_b32 s11, s11, 2
  s_or_b32 s10, s10, s11
  s_lshl_b32 s10, s10, 13
  s_lshl_b32 s11, s3, 11
  s_add_u32 s10, s10, s11
  v_add_u32 v44, s10, v1
  s_lshl_b32 s10, s13, 11
  s_lshl_b32 s11, s3, 9
  s_add_u32 s10, s10, s11
  s_add_u32 s10, s10, 655360
  s_lshl_b32 s11, s27, 13
  s_add_u32 s10, s10, s11
  v_lshrrev_b32 v45, 2, v2
  v_lshl_add_u32 v45, v45, 4, s10
  s_mov_b64 s[86:87], -1
  s_mov_b64 s[88:89], -1
  s_mov_b32 s83, 20000
L_la_9:
  s_mov_b64 exec, s[86:87]
  buffer_load_dwordx4 v[32:35], v45, s[60:63], 0 offen sc1
  buffer_load_dwordx4 v[36:39], v45, s[60:63], 0 offen offset:256 sc1
  s_cmp_eq_u64 s[88:89], 0
  s_cbranch_scc1 L_lask_10
  s_mov_b64 exec, s[88:89]
  buffer_load_dwordx4 v[24:27], v44, s[60:63], 0 offen sc1
  buffer_load_dwordx4 v[28:31], v44, s[60:63], 0 offen offset:1024 sc1
L_lask_10:
  s_waitcnt vmcnt(0)
  s_mov_b64 exec, s[88:89]
  v_xor_b32 v24, s18, v24
  v_xor_b32 v25, s19, v25
  v_xor_b32 v26, s20, v26
  v_xor_b32 v27, s21, v27
  v_xor_b32 v28, s18, v28
  v_xor_b32 v29, s19, v29
  v_xor_b32 v30, s20, v30
  v_xor_b32 v31, s21, v31
  v_or3_b32 v46, v24, v25, v26
  v_or3_b32 v46, v46, v27, v28
  v_or3_b32 v46, v46, v29, v30
  v_or_b32 v46, v46, v31
  v_and_b32 v46, 0x3ff, v46
  v_cmp_ne_u32 vcc, 0, v46
  s_mov_b64 s[88:89], vcc
  s_mov_b64 exec, s[86:87]
  v_xor_b32 v32, s22, v32
  v_xor_b32 v33, s19, v33
  v_xor_b32 v34, s23, v34
  v_xor_b32 v35, s23, v35
  v_xor_b32 v36, s22, v36
  v_xor_b32 v37, s19, v37
  v_xor_b32 v38, s23, v38
  v_xor_b32 v39, s23, v39
  v_or_b32 v46, v32, v36
  v_and_b32 v46, 0xffff, v46
  v_or_b32 v47, v33, v37
  v_and_b32 v47, 0x3ff, v47
  v_or3_b32 v46, v46, v47, v34
  v_or3_b32 v46, v46, v35, v38
  v_or_b32 v46, v46, v39
  v_cmp_ne_u32 vcc, 0, v46
  s_mov_b64 s[86:87], vcc
  s_sub_u32 s83, s83, 1
  s_cbranch_scc1 L_lax_11
  s_cmp_eq_u64 s[86:87], 0
  s_cbranch_scc0 L_la_9
L_lax_11:
  s_cmp_eq_u64 s[88:89], 0
  s_cbranch_scc1 L_lw_14
  s_mov_b64 exec, s[88:89]
  buffer_load_dwordx4 v[24:27], v44, s[60:63], 0 offen sc1
  buffer_load_dwordx4 v[28:31], v44, s[60:63], 0 offen offset:1024 sc1
L_lw_14:
  s_mov_b64 exec, -1
  s_nop 1
  v_max_f32_dpp v46, v32, v32 row_ror:4 row_mask:0xf bank_mask:0xf
  v_max_f32_dpp v47, v36, v36 row_ror:4 row_mask:0xf bank_mask:0xf
  s_nop 0
  v_max_f32_dpp v46, v46, v46 row_ror:8 row_mask:0xf bank_mask:0xf
  v_max_f32_dpp v47, v47, v47 row_ror:8 row_mask:0xf bank_mask:0xf
  v_sub_f32 v48, v32, v46
  v_sub_f32 v49, v36, v47
  v_mul_f32 v48, 0x3fb8aa3b, v48
  v_mul_f32 v49, 0x3fb8aa3b, v49
  v_exp_f32 v48, v48
  v_exp_f32 v49, v49
  v_mul_f32 v46, v48, v33
  v_mul_f32 v47, v49, v37
  s_nop 0
  v_add_f32_dpp v46, v46, v46 row_ror:4 row_mask:0xf bank_mask:0xf
  v_add_f32_dpp v47, v47, v47 row_ror:4 row_mask:0xf bank_mask:0xf
  s_nop 0
  v_add_f32_dpp v46, v46, v46 row_ror:8 row_mask:0xf bank_mask:0xf
  v_add_f32_dpp v47, v47, v47 row_ror:8 row_mask:0xf bank_mask:0xf
  v_rcp_f32 v46, v46
  v_rcp_f32 v47, v47
  v_mul_f32 v48, v48, v46
  v_mul_f32 v49, v49, v47
  s_cmp_eq_u64 s[88:89], 0
  s_cbranch_scc1 L_lbx_13
  s_mov_b64 exec, s[88:89]
L_lb_12:
  s_waitcnt vmcnt(0)
  v_xor_b32 v24, s18, v24
  v_xor_b32 v25, s19, v25
  v_xor_b32 v26, s20, v26
  v_xor_b32 v27, s21, v27
  v_xor_b32 v28, s18, v28
  v_xor_b32 v29, s19, v29
  v_xor_b32 v30, s20, v30
  v_xor_b32 v31, s21, v31
  v_or3_b32 v46, v24, v25, v26
  v_or3_b32 v46, v46, v27, v28
  v_or3_b32 v46, v46, v29, v30
  v_or_b32 v46, v46, v31
  v_and_b32 v46, 0x3ff, v46
  v_cmp_ne_u32 vcc, 0, v46
  s_sub_u32 s83, s83, 1
  s_cbranch_scc1 L_lbx_13
  s_nop 0
  s_cbranch_vccz L_lbx_13
  s_and_b64 exec, exec, vcc
  buffer_load_dwordx4 v[24:27], v44, s[60:63], 0 offen sc1
  buffer_load_dwordx4 v[28:31], v44, s[60:63], 0 offen offset:1024 sc1
  s_branch L_lb_12
L_lbx_13:
  s_mov_b64 exec, -1
  v_mul_f32 v24, v24, v48
  v_mul_f32 v25, v25, v48
  v_mul_f32 v26, v26, v48
  v_mul_f32 v27, v27, v48
  v_fma_f32 v24, v28, v49, v24
  v_fma_f32 v25, v29, v49, v25
  v_fma_f32 v26, v30, v49, v26
  v_fma_f32 v27, v31, v49, v27
  s_nop 1
  v_permlane32_swap_b32 v24, v26
  v_permlane32_swap_b32 v25, v27
  s_nop 0
  v_add_f32 v24, v24, v26
  v_add_f32 v25, v25, v27
  s_nop 1
  v_permlane16_swap_b32 v24, v25
  s_nop 0
  v_add_f32 v24, v24, v25
  s_nop 1
  v_add_f32_dpp v24, v24, v24 row_ror:8 row_mask:0xf bank_mask:0xf
  s_nop 1
  v_add_f32_dpp v24, v24, v24 row_ror:4 row_mask:0xf bank_mask:0xf
  s_mov_b32 exec_lo, 0xf000f
  s_mov_b32 exec_hi, 0xf000f
  ds_write_b32 v53, v24
  s_mov_b64 exec, -1
  s_waitcnt lgkmcnt(0)
  s_barrier
  s_cmp_ge_u32 s3, 2
  s_cbranch_scc1 L_fin
  ds_read_b128 v[24:27], v52
  v_lshlrev_b32 v222, 16, v222
  s_waitcnt lgkmcnt(0)
  v_add_f32 v24, v24, v25
  v_add_f32 v26, v26, v27
  v_add_f32 v24, v24, v26
  v_cvt_pk_bf16_f32 v24, v24, v24
  v_and_b32 v24, 0xffff0000, v24
  v_add_f32 v24, v24, v222
  v_cvt_pk_bf16_f32 v223, v24, v24
  v_and_b32 v223, 0xffff0000, v223
  s_cmp_eq_u32 s3, 0
  s_cbranch_scc1 L_w0_15
  v_or_b32 v24, s22, v223
  s_lshl_b32 s11, s85, 6
  s_add_u32 s11, s11, 659456
  v_and_b32 v46, 15, v2
  v_lshl_add_u32 v46, v46, 2, s11
  v_lshrrev_b32 v47, 4, v2
  v_lshl_add_u32 v46, v47, 13, v46
  s_mov_b32 exec_lo, 0xffffffff
  s_mov_b32 exec_hi, 0x0
  buffer_store_dword v24, v46, s[60:63], 0 offen sc1
  s_mov_b64 exec, -1
  s_branch L_fin
L_w0_15:
  s_lshl_b32 s10, s27, 13
  s_add_u32 s10, s10, 524288
  s_lshr_b32 s11, s85, 3
  s_lshl_b32 s11, s11, 8
  s_add_u32 s10, s10, s11
  s_and_b32 s11, s85, 3
  s_lshl_b32 s11, s11, 6
  s_add_u32 s10, s10, s11
  v_and_b32 v46, 3, v2
  v_lshl_add_u32 v46, v46, 4, s10
  v_lshrrev_b32 v47, 2, v2
  v_lshrrev_b32 v44, 2, v47
  v_lshl_add_u32 v44, v44, 14, v46
  v_and_b32 v47, 3, v47
  v_lshl_add_u32 v44, v47, 11, v44
  v_lshrrev_b32 v47, 2, v2
  v_add_u32 v47, 14, v47
  v_lshrrev_b32 v45, 2, v47
  v_lshl_add_u32 v45, v45, 14, v46
  v_and_b32 v47, 3, v47
  v_lshl_add_u32 v45, v47, 11, v45
  v_mov_b32 v24, 0
  v_mov_b32 v25, 0
  v_mov_b32 v26, 0
  v_mov_b32 v27, 0
  v_mov_b32 v28, 0
  v_mov_b32 v29, 0
  v_mov_b32 v30, 0
  v_mov_b32 v31, 0
  v_lshlrev_b32 v221, 16, v221
  s_mov_b32 exec_lo, 0xffffffff
  s_mov_b32 exec_hi, 0xffffff
  s_mov_b32 s83, 20000
L_poll_p2_16:
  buffer_load_dwordx4 v[24:27], v44, s[60:63], 0 offen sc1
  buffer_load_dwordx4 v[28:31], v45, s[60:63], 0 offen sc1
  s_waitcnt vmcnt(0)
  v_xor_b32 v24, s18, v24
  v_xor_b32 v25, s19, v25
  v_xor_b32 v26, s20, v26
  v_xor_b32 v27, s21, v27
  s_branch L_over_6
L_stub_6:
  s_branch L_back_1
L_over_6:
  v_xor_b32 v28, s18, v28
  v_xor_b32 v29, s19, v29
  v_xor_b32 v30, s20, v30
  v_xor_b32 v31, s21, v31
  v_or3_b32 v46, v24, v25, v26
  v_or3_b32 v46, v46, v27, v28
  v_or3_b32 v46, v46, v29, v30
  v_or_b32 v46, v46, v31
  v_and_b32 v46, 0x3ff, v46
  v_cmp_ne_u32 vcc, 0, v46
  s_sub_u32 s83, s83, 1
  s_cbranch_scc1 L_pollx_p2_17
  s_nop 0
  s_cbranch_vccz L_pollx_p2_17
  s_and_b64 exec, exec, vcc
  s_branch L_poll_p2_16
L_pollx_p2_17:
  s_mov_b64 exec, -1
  s_cmp_lg_u32 s85, 0
  s_cbranch_scc1 L_notag_18
  v_mov_b32 v48, s26
  v_mov_b32 v49, 0xc0000
  s_sub_u32 s10, s60, s40
  v_subrev_u32 v49, s10, v49
  s_mov_b32 exec_lo, 0x1
  s_mov_b32 exec_hi, 0x0
  buffer_store_dword v48, v49, s[60:63], 0 offen
  s_mov_b64 exec, -1
L_notag_18:
  v_add_f32 v24, v24, v28
  v_add_f32 v25, v25, v29
  v_add_f32 v26, v26, v30
  v_add_f32 v27, v27, v31
  s_nop 1
  v_permlane32_swap_b32 v24, v26
  v_permlane32_swap_b32 v25, v27
  s_nop 0
  v_add_f32 v24, v24, v26
  v_add_f32 v25, v25, v27
  s_nop 1
  v_permlane16_swap_b32 v24, v25
  s_nop 0
  v_add_f32 v24, v24, v25
  s_nop 1
  v_add_f32_dpp v24, v24, v24 row_ror:8 row_mask:0xf bank_mask:0xf
  s_nop 1
  v_add_f32_dpp v24, v24, v24 row_ror:4 row_mask:0xf bank_mask:0xf
  v_cvt_pk_bf16_f32 v24, v24, v24
  v_and_b32 v24, 0xffff0000, v24
  v_add_f32 v24, v24, v221
  v_cvt_pk_bf16_f32 v24, v24, v24
  v_and_b32 v24, 0xffff0000, v24
  v_add_f32 v24, v24, v223
  v_mov_b32 v46, v24
  s_nop 1
  v_permlane16_swap_b32 v24, v46
  s_nop 0
  v_cvt_pk_bf16_f32 v24, v24, v46
  s_mov_b32 exec_lo, 0xf
  s_mov_b32 exec_hi, 0xf
  buffer_store_dword v24, v55, s[76:79], 0 offen
  s_mov_b64 exec, -1
L_fin:
  s_waitcnt vmcnt(0)
L_end:
  s_endpgm
.section .rodata,"a"
.p2align 6
.amdhsa_kernel sequential_preLN__mha_block_cached__mixer_channel_mlp__decode_kernel
  .amdhsa_next_free_vgpr 512
  .amdhsa_next_free_sgpr 102
  .amdhsa_accum_offset 256
  .amdhsa_group_segment_fixed_size 0
  .amdhsa_kernarg_size 104
  .amdhsa_user_sgpr_count 2
  .amdhsa_user_sgpr_kernarg_segment_ptr 1
  .amdhsa_system_sgpr_workgroup_id_x 1
.end_amdhsa_kernel
```
